```python
import torch

def _softmax(x, axis=-1):
    return torch.softmax(x, dim=axis)
def _gelu(x):
    return torch.nn.functional.gelu(x, approximate="tanh")
def _silu(x):
    return torch.nn.functional.silu(x)
def _sigmoid(x):
    return torch.sigmoid(x)
def _layernorm(x, axis=-1, eps=1e-5):
    m = x.mean(dim=axis, keepdim=True)
    v = x.var(dim=axis, keepdim=True, unbiased=False)
    return (x - m) / torch.sqrt(v + eps)
def _scatter_add(tgt, idx, src, axis=0):
    return tgt.clone().index_add_(axis, idx, src)
def _segment_sum(src, seg, n):
    out = torch.zeros((n,) + src.shape[1:], dtype=src.dtype)
    return out.index_add_(0, seg, src)
def _pad(x, pw):
    flat = tuple(v for pair in reversed(pw) for v in pair)
    return torch.nn.functional.pad(x, flat)

kernel_name = 'sequential_preLN__gqa_block_cached__dense_activation_squared_relu__decode'

def setup_inputs():

    _w = (lambda a: (lambda t: t.to(torch.bfloat16) if t.is_floating_point() else t)(torch.as_tensor(a)))
    def _A_setup():
        B, Sq, D = 1, 1, 576
        Hq, Hkv, Sk, Dh = 32, 16, 65536, 128
        assert Hq % Hkv == 0, (Hq, Hkv)
        return {
            "x": _w((lambda *s: torch.randn(*s, dtype=torch.bfloat16) * 0.05)(B, Sq, D)),
            "k_cache": _w((lambda *s: torch.randn(*s, dtype=torch.bfloat16) * 3.2)(B, Hkv, Sk, Dh)),
            "v_cache": _w((lambda *s: torch.randn(*s, dtype=torch.bfloat16) * 0.4)(B, Hkv, Sk, Dh)),
            "wq": _w((lambda *s: torch.randn(*s, dtype=torch.bfloat16) * 3.2)(D, Hq * Dh) * (D ** -0.5)),
            "wo": _w((lambda *s: torch.randn(*s, dtype=torch.bfloat16) * 0.4)(Hq * Dh, D) * ((Hq * Dh) ** -0.5)),
        }
    _A_in = _A_setup()

    def _B_setup():
        B, S, D, F = 1, 1, 576, 4608
        return {
            "x": _w((lambda *s: torch.randn(*s, dtype=torch.bfloat16) * 0.05)(B, S, D)),
            "w1": _w((lambda *s: torch.randn(*s, dtype=torch.bfloat16) * 0.05)(D, F)),
            "b1": _w((lambda *s: torch.randn(*s, dtype=torch.bfloat16) * 0.05)(F)),
            "w2": _w((lambda *s: torch.randn(*s, dtype=torch.bfloat16) * 0.05)(F, D)),
            "b2": _w((lambda *s: torch.randn(*s, dtype=torch.bfloat16) * 0.05)(D)),
        }
    _B_in = _B_setup()

    return {
        "A_x": _A_in["x"],
        "A_k_cache": _A_in["k_cache"],
        "A_v_cache": _A_in["v_cache"],
        "A_wq": _A_in["wq"],
        "A_wo": _A_in["wo"],
        "B_x": _B_in["x"],
        "B_w1": _B_in["w1"],
        "B_b1": _B_in["b1"],
        "B_w2": _B_in["w2"],
        "B_b2": _B_in["b2"],
    }

def reference(A_x, A_k_cache, A_v_cache, A_wq, A_wo, B_x, B_w1, B_b1, B_w2, B_b2):
    def _A_ref(x, k_cache, v_cache, wq, wo):
        B, Sq, D = x.shape
        Hq, Dh = 32, 128
        Hkv = k_cache.shape[1]
        rep = Hq // Hkv
        q = (lambda x, *d: x.permute(*d))((x @ wq).reshape(B, Sq, Hq, Dh), 0, 2, 1, 3)
        k = (lambda x, n, axis: torch.repeat_interleave(x, n, dim=axis))(k_cache, rep, axis=1)
        v = (lambda x, n, axis: torch.repeat_interleave(x, n, dim=axis))(v_cache, rep, axis=1)
        scores = torch.einsum("bhqd,bhkd->bhqk", q, k) * (Dh ** -0.5)
        p = _softmax(scores, axis=-1)
        o = torch.einsum("bhqk,bhkd->bhqd", p, v)
        return (lambda x, *d: x.permute(*d))(o, 0, 2, 1, 3).reshape(B, Sq, Hq * Dh) @ wo

    def _B_ref(x, w1, b1, w2, b2):
        h = torch.einsum("bsd,df->bsf", x, w1) + b1
        zero = torch.zeros_like(h)
        r = torch.where(h > zero, h, zero)
        h = r * r
        out = torch.einsum("bsf,fd->bsd", h, w2) + b2
        return out

    x = A_x
    h = x + _A_ref(_layernorm(x, axis=-1), A_k_cache, A_v_cache, A_wq, A_wo)
    h2 = h + _B_ref(_layernorm(h, axis=-1), B_w1, B_b1, B_w2, B_b2)
    return h2
```

```asm
; @launch grid=(256,1,1) block=(512,1,1) lds=120128
.amdgcn_target "amdgcn-amd-amdhsa--gfx950"
.text
.globl sequential_preLN__gqa_block_cached__dense_activation_squared_relu__decode_kernel
.p2align 8
.type sequential_preLN__gqa_block_cached__dense_activation_squared_relu__decode_kernel,@function
sequential_preLN__gqa_block_cached__dense_activation_squared_relu__decode_kernel:
    s_mov_b32 s93, 0
    s_cmp_ge_u32 s2, 256
    s_cbranch_scc1 L_end
    s_memrealtime s[84:85]
    s_load_dwordx4 s[4:7], s[0:1], 8
    s_load_dwordx2 s[8:9], s[0:1], 96
    s_load_dwordx2 s[60:61], s[0:1], 0
    s_load_dwordx4 s[64:67], s[0:1], 24
    s_load_dwordx4 s[72:75], s[0:1], 48
    s_load_dwordx4 s[76:79], s[0:1], 64
    s_load_dwordx4 s[80:83], s[0:1], 80
    v_lshrrev_b32 v1, 6, v0
    v_and_b32 v2, 63, v0
    s_nop 0
    v_readfirstlane_b32 s3, v1
    s_lshr_b32 s10, s2, 4
    s_cmp_eq_u32 s3, 0
    s_cbranch_scc1 L_c0
    v_and_b32 v3, 3, v2
    v_lshlrev_b32 v3, 4, v3
    v_bfe_u32 v4, v2, 2, 2
    v_lshl_add_u32 v3, v4, 8, v3
    v_lshrrev_b32 v4, 4, v2
    v_lshlrev_b32 v5, 4, v4
    v_lshl_add_u32 v3, v4, 6, v3
    v_lshlrev_b32 v6, 4, v2
    s_and_b32 s89, s2, 15
    s_lshl_b32 s89, s89, 20
    s_lshl_b32 s88, s3, 15
    s_add_u32 s88, s88, s89
    s_lshl_b32 s10, s10, 24
    s_mov_b32 s14, 16777216
    s_mov_b32 s15, 0x00020000
    s_mov_b32 s62, 0x0000ffff
    s_mov_b32 s63, 0x0000ffff
    v_mov_b32 v63, 0
    v_mov_b32 v62, 64
    v_lshlrev_b32 v7, 2, v2
    ds_write_b32 v63, v63 offset:5632
    ds_write_b32 v63, v62 offset:5636
    ds_write_b32 v63, v63 offset:5640
    ds_write_b32 v63, v63 offset:5644
    ds_write_b32 v63, v63 offset:5648
    v_mov_b32 v58, 0
    v_mov_b32 v59, 0
    v_mov_b32 v60, 0
    v_mov_b32 v61, 0
    ds_write_b128 v6, v[58:61] offset:14144
    v_mov_b32 v57, 1
    s_sub_u32 s11, s3, 1
    s_lshl_b32 s11, s11, 10
    s_add_u32 s11, s11, 98624
    v_mov_b32 v20, -1
    v_mov_b32 v21, -1
    v_mov_b32 v22, -1
    v_mov_b32 v23, -1
    v_add_u32 v24, s11, v6
    ds_write_b128 v24, v[20:23] offset:0
    ds_write_b128 v24, v[20:23] offset:7168
    ds_write_b128 v24, v[20:23] offset:14336
    s_waitcnt lgkmcnt(0)
    s_waitcnt lgkmcnt(0)
    s_add_u32 s12, s4, s10
    s_addc_u32 s13, s5, 0
    s_and_b32 s13, s13, 0xffff
    s_barrier
    buffer_load_dwordx4 v[64:67], v3, s[12:15], s88 offen offset:0 nt
    buffer_load_dwordx4 v[68:71], v3, s[12:15], s88 offen offset:1024 nt
    s_mov_b64 exec, s[62:63]
    buffer_load_dwordx4 v[72:75], v3, s[12:15], s88 offen offset:2048 nt
    buffer_load_dwordx4 v[76:79], v3, s[12:15], s88 offen offset:3072 nt
    s_not_b64 exec, exec
    buffer_load_dwordx4 v[72:75], v3, s[12:15], s88 offen offset:2048 nt
    buffer_load_dwordx4 v[76:79], v3, s[12:15], s88 offen offset:3072 nt
    s_mov_b64 exec, -1
    s_branch L_rest
L_c0:
    s_setprio 3
    v_lshlrev_b32 v7, 1, v2
    v_lshrrev_b32 v18, 3, v2
    v_lshlrev_b32 v17, 13, v18
    v_and_b32 v19, 7, v2
    v_lshl_add_u32 v17, v19, 4, v17
    s_bfe_u32 s68, s2, 0x20002
    s_mul_i32 s62, s68, 1179648
    s_lshl_b32 s63, s10, 9
    s_add_u32 s62, s62, s63
    s_and_b32 s63, s2, 3
    s_lshl_b32 s63, s63, 7
    s_add_u32 s62, s62, s63
    s_mov_b32 s26, 1152
    s_mov_b32 s27, 0x00020000
    s_mov_b32 s30, 4718592
    s_mov_b32 s31, 0x00020000
    s_mov_b32 s63, 65536
    s_waitcnt lgkmcnt(0)
    s_mov_b32 s24, s60
    s_and_b32 s25, s61, 0xffff
    s_mov_b32 s28, s64
    s_and_b32 s29, s65, 0xffff
    buffer_load_ushort v8, v7, s[24:27], 0 offen offset:0
    buffer_load_ushort v9, v7, s[24:27], 0 offen offset:128
    buffer_load_ushort v10, v7, s[24:27], 0 offen offset:256
    buffer_load_ushort v11, v7, s[24:27], 0 offen offset:384
    buffer_load_ushort v12, v7, s[24:27], 0 offen offset:512
    buffer_load_ushort v13, v7, s[24:27], 0 offen offset:640
    buffer_load_ushort v14, v7, s[24:27], 0 offen offset:768
    buffer_load_ushort v15, v7, s[24:27], 0 offen offset:896
    buffer_load_ushort v16, v7, s[24:27], 0 offen offset:1024
    buffer_load_dwordx4 v[64:67], v17, s[28:31], s62 offen nt
    s_add_u32 s62, s62, s63
    buffer_load_dwordx4 v[68:71], v17, s[28:31], s62 offen nt
    s_add_u32 s62, s62, s63
    buffer_load_dwordx4 v[72:75], v17, s[28:31], s62 offen nt
    s_add_u32 s62, s62, s63
    buffer_load_dwordx4 v[76:79], v17, s[28:31], s62 offen nt
    s_add_u32 s62, s62, s63
    buffer_load_dwordx4 v[80:83], v17, s[28:31], s62 offen nt
    s_add_u32 s62, s62, s63
    buffer_load_dwordx4 v[84:87], v17, s[28:31], s62 offen nt
    s_add_u32 s62, s62, s63
    buffer_load_dwordx4 v[88:91], v17, s[28:31], s62 offen nt
    s_add_u32 s62, s62, s63
    buffer_load_dwordx4 v[92:95], v17, s[28:31], s62 offen nt
    s_add_u32 s62, s62, s63
    buffer_load_dwordx4 v[96:99], v17, s[28:31], s62 offen nt
    s_add_u32 s62, s62, s63
    buffer_load_dwordx4 v[100:103], v17, s[28:31], s62 offen nt
    s_add_u32 s62, s62, s63
    buffer_load_dwordx4 v[104:107], v17, s[28:31], s62 offen nt
    s_add_u32 s62, s62, s63
    buffer_load_dwordx4 v[108:111], v17, s[28:31], s62 offen nt
    s_add_u32 s62, s62, s63
    buffer_load_dwordx4 v[112:115], v17, s[28:31], s62 offen nt
    s_add_u32 s62, s62, s63
    buffer_load_dwordx4 v[116:119], v17, s[28:31], s62 offen nt
    s_add_u32 s62, s62, s63
    buffer_load_dwordx4 v[120:123], v17, s[28:31], s62 offen nt
    s_add_u32 s62, s62, s63
    buffer_load_dwordx4 v[124:127], v17, s[28:31], s62 offen nt
    s_add_u32 s62, s62, s63
    buffer_load_dwordx4 v[128:131], v17, s[28:31], s62 offen nt
    s_add_u32 s62, s62, s63
    buffer_load_dwordx4 v[132:135], v17, s[28:31], s62 offen nt
    s_barrier
L_rest:
    s_lshr_b32 s10, s2, 4
    s_lshl_b32 s10, s10, 24
    s_add_u32 s4, s4, s10
    s_addc_u32 s5, s5, 0
    s_add_u32 s6, s6, s10
    s_addc_u32 s7, s7, 0
    s_and_b32 s89, s2, 15
    s_lshr_b32 s10, s2, 4
    s_mul_i32 s11, s10, 1
    s_add_u32 s11, s11, s89
    s_and_b32 s11, s11, 15
    s_mul_i32 s100, s10, 9
    s_add_u32 s100, s100, s11
    s_sub_u32 s101, s11, 9
    s_lshl_b32 s101, s101, 4
    s_add_u32 s101, s101, s10
    s_cmp_lt_u32 s11, 9
    s_cselect_b32 s100, s100, -1
    s_cselect_b32 s101, -1, s101
    s_sub_u32 s95, s11, 12
    s_cmp_ge_u32 s11, 12
    s_cselect_b32 s95, s95, -1
    s_mov_b64 s[86:87], -1
    s_add_u32 s11, s89, s10
    s_and_b32 s11, s11, 7
    s_lshr_b32 s62, s89, 3
    s_lshl_b32 s63, s11, 4
    s_add_u32 s63, s63, s10
    s_lshl_b32 s63, s63, 1
    s_add_u32 s63, s63, s62
    s_cmp_lt_u32 s63, 144
    s_cselect_b32 s100, s63, -1
    s_sub_u32 s101, s63, 144
    s_cmp_lt_u32 s101, 18
    s_cselect_b32 s101, s101, -1
    s_sub_u32 s95, s11, 6
    s_lshl_b32 s95, s95, 1
    s_add_u32 s95, s95, s62
    s_cmp_ge_u32 s11, 6
    s_cselect_b32 s95, s95, -1
    s_lshl_b32 s89, s89, 20
    s_lshl_b32 s88, s3, 15
    s_add_u32 s88, s88, s89
    s_mov_b32 s12, s4
    s_and_b32 s13, s5, 0xffff
    s_mov_b32 s14, 16777216
    s_mov_b32 s15, 0x00020000
    s_mov_b32 s16, s6
    s_and_b32 s17, s7, 0xffff
    s_mov_b32 s18, 16777216
    s_mov_b32 s19, 0x00020000
    s_mov_b32 s20, s8
    s_and_b32 s21, s9, 0xffff
    s_mov_b32 s22, 4194304
    s_mov_b32 s23, 0x00020000
    s_mov_b32 s24, s60
    s_and_b32 s25, s61, 0xffff
    s_mov_b32 s26, 1152
    s_mov_b32 s27, 0x00020000
    s_mov_b32 s28, s64
    s_and_b32 s29, s65, 0xffff
    s_mov_b32 s30, 4718592
    s_mov_b32 s31, 0x00020000
    s_mov_b32 s32, s66
    s_and_b32 s33, s67, 0xffff
    s_mov_b32 s34, 4718592
    s_mov_b32 s35, 0x00020000
    s_mov_b32 s36, s72
    s_and_b32 s37, s73, 0xffff
    s_mov_b32 s38, 5308416
    s_mov_b32 s39, 0x00020000
    s_mov_b32 s44, s74
    s_and_b32 s45, s75, 0xffff
    s_mov_b32 s46, 9216
    s_mov_b32 s47, 0x00020000
    s_mov_b32 s40, s76
    s_and_b32 s41, s77, 0xffff
    s_mov_b32 s42, 5308416
    s_mov_b32 s43, 0x00020000
    s_mov_b32 s48, s78
    s_and_b32 s49, s79, 0xffff
    s_mov_b32 s50, 1152
    s_mov_b32 s51, 0x00020000
    s_mov_b32 s52, s80
    s_and_b32 s53, s81, 0xffff
    s_mov_b32 s54, 1152
    s_mov_b32 s55, 0x00020000
    s_mov_b32 s56, s82
    s_and_b32 s57, s83, 0xffff
    s_mov_b32 s58, 256
    s_mov_b32 s59, 0x00020000
    s_mov_b32 s76, s84
    s_mov_b32 s4, 0x0000ffff
    s_mov_b32 s5, 0x0000ffff
    s_mov_b32 s6, 0x0f0f0f0f
    s_mov_b32 s7, 0x0f0f0f0f
    v_and_b32 v3, 3, v2
    v_lshlrev_b32 v3, 4, v3
    v_bfe_u32 v4, v2, 2, 2
    v_lshl_add_u32 v3, v4, 8, v3
    v_lshrrev_b32 v4, 4, v2
    v_lshlrev_b32 v5, 4, v4
    v_lshl_add_u32 v3, v4, 6, v3
    v_lshlrev_b32 v6, 4, v2
    v_and_b32 v7, 7, v2
    v_lshl_add_u32 v7, v4, 3, v7
    v_lshlrev_b32 v7, 1, v7
    s_lshl_b32 s62, s100, 6
    s_cmp_lt_u32 s100, 144
    s_cselect_b32 s62, s62, 0
    buffer_load_ushort v249, v7, s[44:47], s62 offen
    v_and_b32 v7, 7, v2
    v_lshl_add_u32 v248, v7, 2, v4
    v_lshlrev_b32 v7, 1, v248
    s_lshl_b32 s62, s101, 6
    s_cmp_lt_u32 s101, 18
    s_cselect_b32 s62, s62, 0
    buffer_load_ushort v250, v7, s[24:27], s62 offen
    buffer_load_ushort v251, v7, s[48:51], s62 offen
    s_cmp_eq_u32 s3, 0
    s_cbranch_scc1 L_crit
    s_setprio 1
    s_cmp_lt_u32 s3, 4
    s_cbranch_scc1 L_lowprio
    s_setprio 2
L_lowprio:
    s_sub_u32 s62, s3, 1
    s_lshr_b32 s68, s2, 4
    s_lshl_b32 s68, s68, 2
    s_add_u32 s68, s68, s95
    s_mul_i32 s68, s68, 73728
    s_cmp_ge_u32 s95, 0
    s_cbranch_scc1 L_dma_wo_done
L_dma_wo:
    s_lshl_b32 s69, s62, 10
    s_add_u32 s63, s68, s69
    s_add_u32 m0, s69, 24640
    s_add_u32 s62, s62, 7
    buffer_load_dwordx4 v6, s[32:35], s63 offen nt lds
    s_cmp_lt_u32 s62, 72
    s_cbranch_scc1 L_dma_wo
L_dma_wo_done:
    s_cmp_ge_u32 s100, 0
    s_cbranch_scc1 L_dma_done
    v_lshrrev_b32 v19, 2, v2
    s_movk_i32 s62, 9216
    v_mul_lo_u32 v19, v19, s62
    v_and_b32 v32, 3, v2
    v_lshlrev_b32 v32, 4, v32
    s_lshl_b32 s62, s100, 6
    v_add3_u32 v19, v19, v32, s62
    s_sub_u32 s62, s3, 1
    s_mul_i32 s68, s100, 36864
L_dma_w:
    s_lshl_b32 s69, s62, 10
    s_mul_i32 s63, s62, 147456
    s_add_u32 m0, s69, 24640
    s_nop 0
    buffer_load_dwordx4 v19, s[36:39], s63 offen nt lds
    s_add_u32 s63, s68, s69
    s_add_u32 m0, s69, 61504
    s_add_u32 s62, s62, 7
    buffer_load_dwordx4 v6, s[40:43], s63 offen nt lds
    s_cmp_lt_u32 s62, 36
    s_cbranch_scc1 L_dma_w
L_dma_done:
    s_add_u32 s62, s88, 4096
    buffer_load_dwordx4 v[80:83], v3, s[12:15], s62 offen offset:0 nt
    buffer_load_dwordx4 v[84:87], v3, s[12:15], s62 offen offset:1024 nt
    s_mov_b64 exec, s[4:5]
    buffer_load_dwordx4 v[88:91], v3, s[12:15], s62 offen offset:2048 nt
    buffer_load_dwordx4 v[92:95], v3, s[12:15], s62 offen offset:3072 nt
    s_not_b64 exec, exec
    buffer_load_dwordx4 v[88:91], v3, s[12:15], s62 offen offset:2048 nt
    buffer_load_dwordx4 v[92:95], v3, s[12:15], s62 offen offset:3072 nt
    s_mov_b64 exec, -1
    s_add_u32 s62, s88, 8192
    buffer_load_dwordx4 v[96:99], v3, s[12:15], s62 offen offset:0 nt
    buffer_load_dwordx4 v[100:103], v3, s[12:15], s62 offen offset:1024 nt
    s_mov_b64 exec, s[4:5]
    buffer_load_dwordx4 v[104:107], v3, s[12:15], s62 offen offset:2048 nt
    buffer_load_dwordx4 v[108:111], v3, s[12:15], s62 offen offset:3072 nt
    s_not_b64 exec, exec
    buffer_load_dwordx4 v[104:107], v3, s[12:15], s62 offen offset:2048 nt
    buffer_load_dwordx4 v[108:111], v3, s[12:15], s62 offen offset:3072 nt
    s_mov_b64 exec, -1
    s_add_u32 s62, s88, 12288
    buffer_load_dwordx4 v[112:115], v3, s[12:15], s62 offen offset:0 nt
    buffer_load_dwordx4 v[116:119], v3, s[12:15], s62 offen offset:1024 nt
    s_mov_b64 exec, s[4:5]
    buffer_load_dwordx4 v[120:123], v3, s[12:15], s62 offen offset:2048 nt
    buffer_load_dwordx4 v[124:127], v3, s[12:15], s62 offen offset:3072 nt
    s_not_b64 exec, exec
    buffer_load_dwordx4 v[120:123], v3, s[12:15], s62 offen offset:2048 nt
    buffer_load_dwordx4 v[124:127], v3, s[12:15], s62 offen offset:3072 nt
    s_mov_b64 exec, -1
    s_add_u32 s62, s88, 16384
    buffer_load_dwordx4 v[128:131], v3, s[12:15], s62 offen offset:0 nt
    buffer_load_dwordx4 v[132:135], v3, s[12:15], s62 offen offset:1024 nt
    s_mov_b64 exec, s[4:5]
    buffer_load_dwordx4 v[136:139], v3, s[12:15], s62 offen offset:2048 nt
    buffer_load_dwordx4 v[140:143], v3, s[12:15], s62 offen offset:3072 nt
    s_not_b64 exec, exec
    buffer_load_dwordx4 v[136:139], v3, s[12:15], s62 offen offset:2048 nt
    buffer_load_dwordx4 v[140:143], v3, s[12:15], s62 offen offset:3072 nt
    s_mov_b64 exec, -1
    s_add_u32 s62, s88, 20480
    buffer_load_dwordx4 v[144:147], v3, s[12:15], s62 offen offset:0 nt
    buffer_load_dwordx4 v[148:151], v3, s[12:15], s62 offen offset:1024 nt
    s_mov_b64 exec, s[4:5]
    buffer_load_dwordx4 v[152:155], v3, s[12:15], s62 offen offset:2048 nt
    buffer_load_dwordx4 v[156:159], v3, s[12:15], s62 offen offset:3072 nt
    s_not_b64 exec, exec
    buffer_load_dwordx4 v[152:155], v3, s[12:15], s62 offen offset:2048 nt
    buffer_load_dwordx4 v[156:159], v3, s[12:15], s62 offen offset:3072 nt
    s_mov_b64 exec, -1
    s_add_u32 s62, s88, 24576
    buffer_load_dwordx4 v[160:163], v3, s[12:15], s62 offen offset:0 nt
    buffer_load_dwordx4 v[164:167], v3, s[12:15], s62 offen offset:1024 nt
    s_mov_b64 exec, s[4:5]
    buffer_load_dwordx4 v[168:171], v3, s[12:15], s62 offen offset:2048 nt
    buffer_load_dwordx4 v[172:175], v3, s[12:15], s62 offen offset:3072 nt
    s_not_b64 exec, exec
    buffer_load_dwordx4 v[168:171], v3, s[12:15], s62 offen offset:2048 nt
    buffer_load_dwordx4 v[172:175], v3, s[12:15], s62 offen offset:3072 nt
    s_mov_b64 exec, -1
    s_add_u32 s62, s88, 28672
    buffer_load_dwordx4 v[176:179], v3, s[12:15], s62 offen offset:0 nt
    buffer_load_dwordx4 v[180:183], v3, s[12:15], s62 offen offset:1024 nt
    s_mov_b64 exec, s[4:5]
    buffer_load_dwordx4 v[184:187], v3, s[12:15], s62 offen offset:2048 nt
    buffer_load_dwordx4 v[188:191], v3, s[12:15], s62 offen offset:3072 nt
    s_not_b64 exec, exec
    buffer_load_dwordx4 v[184:187], v3, s[12:15], s62 offen offset:2048 nt
    buffer_load_dwordx4 v[188:191], v3, s[12:15], s62 offen offset:3072 nt
    s_mov_b64 exec, -1
    v_mov_b32 v40, 0
    s_mov_b32 s70, 0
L_qwait:
    ds_read_b32 v41, v40 offset:5632
    s_waitcnt lgkmcnt(0)
    v_cmp_ne_u32 vcc, 0, v41
    s_add_u32 s70, s70, 1
    s_cbranch_vccnz L_q_ok
    s_sleep 1
    s_cmp_lt_u32 s70, 800000
    s_cbranch_scc1 L_qwait
    s_branch L_q_ok
L_crit:
    v_mov_b32 v63, 0
L_nononce:
    s_lshr_b32 s63, s2, 4
    s_mul_i32 s63, s63, 256
    s_add_u32 s63, s63, 131072
    s_and_b32 s62, s2, 15
    s_cmp_eq_u32 s62, 0
    s_cselect_b32 s62, s63, 0x40000000
    v_mul_u32_u24 v24, 4096, v2
    v_lshlrev_b32 v25, 16, v2
    v_or_b32 v25, 1, v25
    s_mov_b64 exec, 1
    buffer_store_dword v25, v24, s[20:23], s62 offen sc1
    s_mov_b64 exec, -1
    s_waitcnt vmcnt(22)
    v_lshlrev_b32 v8, 16, v8
    v_lshlrev_b32 v9, 16, v9
    v_lshlrev_b32 v10, 16, v10
    v_lshlrev_b32 v11, 16, v11
    v_lshlrev_b32 v12, 16, v12
    v_lshlrev_b32 v13, 16, v13
    v_lshlrev_b32 v14, 16, v14
    v_lshlrev_b32 v15, 16, v15
    v_lshlrev_b32 v16, 16, v16
    v_add_f32 v32, v8, v9
    v_add_f32 v32, v32, v10
    v_add_f32 v32, v32, v11
    v_add_f32 v32, v32, v12
    v_add_f32 v32, v32, v13
    v_add_f32 v32, v32, v14
    v_add_f32 v32, v32, v15
    v_add_f32 v32, v32, v16
    s_nop 1
    v_add_f32_dpp v32, v32, v32 row_shr:1 row_mask:0xf bank_mask:0xf bound_ctrl:0
    s_nop 1
    v_add_f32_dpp v32, v32, v32 row_shr:2 row_mask:0xf bank_mask:0xf bound_ctrl:0
    s_nop 1
    v_add_f32_dpp v32, v32, v32 row_shr:4 row_mask:0xf bank_mask:0xf bound_ctrl:0
    s_nop 1
    v_add_f32_dpp v32, v32, v32 row_shr:8 row_mask:0xf bank_mask:0xf bound_ctrl:0
    s_nop 1
    v_add_f32_dpp v32, v32, v32 row_bcast:15 row_mask:0xa bank_mask:0xf
    s_nop 1
    v_add_f32_dpp v32, v32, v32 row_bcast:31 row_mask:0xc bank_mask:0xf
    s_nop 1
    v_readlane_b32 s62, v32, 63
    s_nop 3
    v_mov_b32 v33, 0x3ae38e39
    v_mul_f32 v33, s62, v33
    v_sub_f32 v34, v8, v33
    v_mul_f32 v32, v34, v34
    v_sub_f32 v34, v9, v33
    v_fmac_f32 v32, v34, v34
    v_sub_f32 v34, v10, v33
    v_fmac_f32 v32, v34, v34
    v_sub_f32 v34, v11, v33
    v_fmac_f32 v32, v34, v34
    v_sub_f32 v34, v12, v33
    v_fmac_f32 v32, v34, v34
    v_sub_f32 v34, v13, v33
    v_fmac_f32 v32, v34, v34
    v_sub_f32 v34, v14, v33
    v_fmac_f32 v32, v34, v34
    v_sub_f32 v34, v15, v33
    v_fmac_f32 v32, v34, v34
    v_sub_f32 v34, v16, v33
    v_fmac_f32 v32, v34, v34
    s_nop 1
    v_add_f32_dpp v32, v32, v32 row_shr:1 row_mask:0xf bank_mask:0xf bound_ctrl:0
    s_nop 1
    v_add_f32_dpp v32, v32, v32 row_shr:2 row_mask:0xf bank_mask:0xf bound_ctrl:0
    s_nop 1
    v_add_f32_dpp v32, v32, v32 row_shr:4 row_mask:0xf bank_mask:0xf bound_ctrl:0
    s_nop 1
    v_add_f32_dpp v32, v32, v32 row_shr:8 row_mask:0xf bank_mask:0xf bound_ctrl:0
    s_nop 1
    v_add_f32_dpp v32, v32, v32 row_bcast:15 row_mask:0xa bank_mask:0xf
    s_nop 1
    v_add_f32_dpp v32, v32, v32 row_bcast:31 row_mask:0xc bank_mask:0xf
    s_nop 1
    v_readlane_b32 s62, v32, 63
    s_nop 3
    v_mov_b32 v34, 0x3ae38e39
    v_mul_f32 v34, s62, v34
    v_cvt_pk_bf16_f32 v33, v33, v33
    v_lshlrev_b32 v33, 16, v33
    v_cvt_pk_bf16_f32 v34, v34, v34
    v_lshlrev_b32 v34, 16, v34
    v_add_f32 v34, 0x3727c5ac, v34
    v_cvt_pk_bf16_f32 v34, v34, v34
    v_lshlrev_b32 v34, 16, v34
    v_sqrt_f32 v34, v34
    s_nop 0
    v_cvt_pk_bf16_f32 v34, v34, v34
    v_lshlrev_b32 v34, 16, v34
    v_rcp_f32 v35, v34
    s_nop 0
    v_sub_f32 v8, v8, v33
    v_cvt_pk_bf16_f32 v8, v8, v8
    v_lshlrev_b32 v8, 16, v8
    v_mul_f32 v36, v8, v35
    v_fma_f32 v37, -v36, v34, v8
    v_fma_f32 v36, v37, v35, v36
    v_cvt_pk_bf16_f32 v8, v36, v36
    v_lshlrev_b32 v8, 16, v8
    v_sub_f32 v9, v9, v33
    v_cvt_pk_bf16_f32 v9, v9, v9
    v_lshlrev_b32 v9, 16, v9
    v_mul_f32 v36, v9, v35
    v_fma_f32 v37, -v36, v34, v9
    v_fma_f32 v36, v37, v35, v36
    v_cvt_pk_bf16_f32 v9, v36, v36
    v_lshlrev_b32 v9, 16, v9
    v_sub_f32 v10, v10, v33
    v_cvt_pk_bf16_f32 v10, v10, v10
    v_lshlrev_b32 v10, 16, v10
    v_mul_f32 v36, v10, v35
    v_fma_f32 v37, -v36, v34, v10
    v_fma_f32 v36, v37, v35, v36
    v_cvt_pk_bf16_f32 v10, v36, v36
    v_lshlrev_b32 v10, 16, v10
    v_sub_f32 v11, v11, v33
    v_cvt_pk_bf16_f32 v11, v11, v11
    v_lshlrev_b32 v11, 16, v11
    v_mul_f32 v36, v11, v35
    v_fma_f32 v37, -v36, v34, v11
    v_fma_f32 v36, v37, v35, v36
    v_cvt_pk_bf16_f32 v11, v36, v36
    v_lshlrev_b32 v11, 16, v11
    v_sub_f32 v12, v12, v33
    v_cvt_pk_bf16_f32 v12, v12, v12
    v_lshlrev_b32 v12, 16, v12
    v_mul_f32 v36, v12, v35
    v_fma_f32 v37, -v36, v34, v12
    v_fma_f32 v36, v37, v35, v36
    v_cvt_pk_bf16_f32 v12, v36, v36
    v_lshlrev_b32 v12, 16, v12
    v_sub_f32 v13, v13, v33
    v_cvt_pk_bf16_f32 v13, v13, v13
    v_lshlrev_b32 v13, 16, v13
    v_mul_f32 v36, v13, v35
    v_fma_f32 v37, -v36, v34, v13
    v_fma_f32 v36, v37, v35, v36
    v_cvt_pk_bf16_f32 v13, v36, v36
    v_lshlrev_b32 v13, 16, v13
    v_sub_f32 v14, v14, v33
    v_cvt_pk_bf16_f32 v14, v14, v14
    v_lshlrev_b32 v14, 16, v14
    v_mul_f32 v36, v14, v35
    v_fma_f32 v37, -v36, v34, v14
    v_fma_f32 v36, v37, v35, v36
    v_cvt_pk_bf16_f32 v14, v36, v36
    v_lshlrev_b32 v14, 16, v14
    v_sub_f32 v15, v15, v33
    v_cvt_pk_bf16_f32 v15, v15, v15
    v_lshlrev_b32 v15, 16, v15
    v_mul_f32 v36, v15, v35
    v_fma_f32 v37, -v36, v34, v15
    v_fma_f32 v36, v37, v35, v36
    v_cvt_pk_bf16_f32 v15, v36, v36
    v_lshlrev_b32 v15, 16, v15
    v_sub_f32 v16, v16, v33
    v_cvt_pk_bf16_f32 v16, v16, v16
    v_lshlrev_b32 v16, 16, v16
    v_mul_f32 v36, v16, v35
    v_fma_f32 v37, -v36, v34, v16
    v_fma_f32 v36, v37, v35, v36
    v_cvt_pk_bf16_f32 v16, v36, v36
    v_lshlrev_b32 v16, 16, v16
    v_lshlrev_b32 v7, 2, v2
    ds_write_b32 v7, v8 offset:0
    ds_write_b32 v7, v9 offset:256
    ds_write_b32 v7, v10 offset:512
    ds_write_b32 v7, v11 offset:768
    ds_write_b32 v7, v12 offset:1024
    ds_write_b32 v7, v13 offset:1280
    ds_write_b32 v7, v14 offset:1536
    ds_write_b32 v7, v15 offset:1792
    ds_write_b32 v7, v16 offset:2048
    s_mul_i32 s62, s68, 144
    v_add_u32 v33, s62, v18
    v_lshlrev_b32 v33, 2, v33
    s_waitcnt lgkmcnt(0)
    ds_read_b32 v34, v33 offset:0
    ds_read_b32 v35, v33 offset:32
    ds_read_b32 v36, v33 offset:64
    ds_read_b32 v37, v33 offset:96
    ds_read_b32 v38, v33 offset:128
    ds_read_b32 v39, v33 offset:160
    ds_read_b32 v40, v33 offset:192
    ds_read_b32 v41, v33 offset:224
    ds_read_b32 v42, v33 offset:256
    ds_read_b32 v43, v33 offset:288
    ds_read_b32 v44, v33 offset:320
    ds_read_b32 v45, v33 offset:352
    ds_read_b32 v46, v33 offset:384
    ds_read_b32 v47, v33 offset:416
    ds_read_b32 v48, v33 offset:448
    ds_read_b32 v49, v33 offset:480
    ds_read_b32 v50, v33 offset:512
    ds_read_b32 v51, v33 offset:544
    v_mov_b32 v52, 0
    v_mov_b32 v53, 0
    v_mov_b32 v54, 0
    v_mov_b32 v55, 0
    v_mov_b32 v56, 0
    v_mov_b32 v57, 0
    v_mov_b32 v58, 0
    v_mov_b32 v59, 0
    s_waitcnt lgkmcnt(0)
    s_waitcnt vmcnt(21)
    v_lshlrev_b32 v60, 16, v64
    v_and_b32 v61, 0xffff0000, v64
    v_fmac_f32 v52, v34, v60
    v_fmac_f32 v53, v34, v61
    v_lshlrev_b32 v60, 16, v65
    v_and_b32 v61, 0xffff0000, v65
    v_fmac_f32 v54, v34, v60
    v_fmac_f32 v55, v34, v61
    v_lshlrev_b32 v60, 16, v66
    v_and_b32 v61, 0xffff0000, v66
    v_fmac_f32 v56, v34, v60
    v_fmac_f32 v57, v34, v61
    v_lshlrev_b32 v60, 16, v67
    v_and_b32 v61, 0xffff0000, v67
    v_fmac_f32 v58, v34, v60
    v_fmac_f32 v59, v34, v61
    s_waitcnt vmcnt(20)
    v_lshlrev_b32 v60, 16, v68
    v_and_b32 v61, 0xffff0000, v68
    v_fmac_f32 v52, v35, v60
    v_fmac_f32 v53, v35, v61
    v_lshlrev_b32 v60, 16, v69
    v_and_b32 v61, 0xffff0000, v69
    v_fmac_f32 v54, v35, v60
    v_fmac_f32 v55, v35, v61
    v_lshlrev_b32 v60, 16, v70
    v_and_b32 v61, 0xffff0000, v70
    v_fmac_f32 v56, v35, v60
    v_fmac_f32 v57, v35, v61
    v_lshlrev_b32 v60, 16, v71
    v_and_b32 v61, 0xffff0000, v71
    v_fmac_f32 v58, v35, v60
    v_fmac_f32 v59, v35, v61
    s_waitcnt vmcnt(19)
    v_lshlrev_b32 v60, 16, v72
    v_and_b32 v61, 0xffff0000, v72
    v_fmac_f32 v52, v36, v60
    v_fmac_f32 v53, v36, v61
    v_lshlrev_b32 v60, 16, v73
    v_and_b32 v61, 0xffff0000, v73
    v_fmac_f32 v54, v36, v60
    v_fmac_f32 v55, v36, v61
    v_lshlrev_b32 v60, 16, v74
    v_and_b32 v61, 0xffff0000, v74
    v_fmac_f32 v56, v36, v60
    v_fmac_f32 v57, v36, v61
    v_lshlrev_b32 v60, 16, v75
    v_and_b32 v61, 0xffff0000, v75
    v_fmac_f32 v58, v36, v60
    v_fmac_f32 v59, v36, v61
    s_waitcnt vmcnt(18)
    v_lshlrev_b32 v60, 16, v76
    v_and_b32 v61, 0xffff0000, v76
    v_fmac_f32 v52, v37, v60
    v_fmac_f32 v53, v37, v61
    v_lshlrev_b32 v60, 16, v77
    v_and_b32 v61, 0xffff0000, v77
    v_fmac_f32 v54, v37, v60
    v_fmac_f32 v55, v37, v61
    v_lshlrev_b32 v60, 16, v78
    v_and_b32 v61, 0xffff0000, v78
    v_fmac_f32 v56, v37, v60
    v_fmac_f32 v57, v37, v61
    v_lshlrev_b32 v60, 16, v79
    v_and_b32 v61, 0xffff0000, v79
    v_fmac_f32 v58, v37, v60
    v_fmac_f32 v59, v37, v61
    s_waitcnt vmcnt(17)
    v_lshlrev_b32 v60, 16, v80
    v_and_b32 v61, 0xffff0000, v80
    v_fmac_f32 v52, v38, v60
    v_fmac_f32 v53, v38, v61
    v_lshlrev_b32 v60, 16, v81
    v_and_b32 v61, 0xffff0000, v81
    v_fmac_f32 v54, v38, v60
    v_fmac_f32 v55, v38, v61
    v_lshlrev_b32 v60, 16, v82
    v_and_b32 v61, 0xffff0000, v82
    v_fmac_f32 v56, v38, v60
    v_fmac_f32 v57, v38, v61
    v_lshlrev_b32 v60, 16, v83
    v_and_b32 v61, 0xffff0000, v83
    v_fmac_f32 v58, v38, v60
    v_fmac_f32 v59, v38, v61
    s_waitcnt vmcnt(16)
    v_lshlrev_b32 v60, 16, v84
    v_and_b32 v61, 0xffff0000, v84
    v_fmac_f32 v52, v39, v60
    v_fmac_f32 v53, v39, v61
    v_lshlrev_b32 v60, 16, v85
    v_and_b32 v61, 0xffff0000, v85
    v_fmac_f32 v54, v39, v60
    v_fmac_f32 v55, v39, v61
    v_lshlrev_b32 v60, 16, v86
    v_and_b32 v61, 0xffff0000, v86
    v_fmac_f32 v56, v39, v60
    v_fmac_f32 v57, v39, v61
    v_lshlrev_b32 v60, 16, v87
    v_and_b32 v61, 0xffff0000, v87
    v_fmac_f32 v58, v39, v60
    v_fmac_f32 v59, v39, v61
    s_waitcnt vmcnt(15)
    v_lshlrev_b32 v60, 16, v88
    v_and_b32 v61, 0xffff0000, v88
    v_fmac_f32 v52, v40, v60
    v_fmac_f32 v53, v40, v61
    v_lshlrev_b32 v60, 16, v89
    v_and_b32 v61, 0xffff0000, v89
    v_fmac_f32 v54, v40, v60
    v_fmac_f32 v55, v40, v61
    v_lshlrev_b32 v60, 16, v90
    v_and_b32 v61, 0xffff0000, v90
    v_fmac_f32 v56, v40, v60
    v_fmac_f32 v57, v40, v61
    v_lshlrev_b32 v60, 16, v91
    v_and_b32 v61, 0xffff0000, v91
    v_fmac_f32 v58, v40, v60
    v_fmac_f32 v59, v40, v61
    s_waitcnt vmcnt(14)
    v_lshlrev_b32 v60, 16, v92
    v_and_b32 v61, 0xffff0000, v92
    v_fmac_f32 v52, v41, v60
    v_fmac_f32 v53, v41, v61
    v_lshlrev_b32 v60, 16, v93
    v_and_b32 v61, 0xffff0000, v93
    v_fmac_f32 v54, v41, v60
    v_fmac_f32 v55, v41, v61
    v_lshlrev_b32 v60, 16, v94
    v_and_b32 v61, 0xffff0000, v94
    v_fmac_f32 v56, v41, v60
    v_fmac_f32 v57, v41, v61
    v_lshlrev_b32 v60, 16, v95
    v_and_b32 v61, 0xffff0000, v95
    v_fmac_f32 v58, v41, v60
    v_fmac_f32 v59, v41, v61
    s_waitcnt vmcnt(13)
    v_lshlrev_b32 v60, 16, v96
    v_and_b32 v61, 0xffff0000, v96
    v_fmac_f32 v52, v42, v60
    v_fmac_f32 v53, v42, v61
    v_lshlrev_b32 v60, 16, v97
    v_and_b32 v61, 0xffff0000, v97
    v_fmac_f32 v54, v42, v60
    v_fmac_f32 v55, v42, v61
    v_lshlrev_b32 v60, 16, v98
    v_and_b32 v61, 0xffff0000, v98
    v_fmac_f32 v56, v42, v60
    v_fmac_f32 v57, v42, v61
    v_lshlrev_b32 v60, 16, v99
    v_and_b32 v61, 0xffff0000, v99
    v_fmac_f32 v58, v42, v60
    v_fmac_f32 v59, v42, v61
    s_waitcnt vmcnt(12)
    v_lshlrev_b32 v60, 16, v100
    v_and_b32 v61, 0xffff0000, v100
    v_fmac_f32 v52, v43, v60
    v_fmac_f32 v53, v43, v61
    v_lshlrev_b32 v60, 16, v101
    v_and_b32 v61, 0xffff0000, v101
    v_fmac_f32 v54, v43, v60
    v_fmac_f32 v55, v43, v61
    v_lshlrev_b32 v60, 16, v102
    v_and_b32 v61, 0xffff0000, v102
    v_fmac_f32 v56, v43, v60
    v_fmac_f32 v57, v43, v61
    v_lshlrev_b32 v60, 16, v103
    v_and_b32 v61, 0xffff0000, v103
    v_fmac_f32 v58, v43, v60
    v_fmac_f32 v59, v43, v61
    s_waitcnt vmcnt(11)
    v_lshlrev_b32 v60, 16, v104
    v_and_b32 v61, 0xffff0000, v104
    v_fmac_f32 v52, v44, v60
    v_fmac_f32 v53, v44, v61
    v_lshlrev_b32 v60, 16, v105
    v_and_b32 v61, 0xffff0000, v105
    v_fmac_f32 v54, v44, v60
    v_fmac_f32 v55, v44, v61
    v_lshlrev_b32 v60, 16, v106
    v_and_b32 v61, 0xffff0000, v106
    v_fmac_f32 v56, v44, v60
    v_fmac_f32 v57, v44, v61
    v_lshlrev_b32 v60, 16, v107
    v_and_b32 v61, 0xffff0000, v107
    v_fmac_f32 v58, v44, v60
    v_fmac_f32 v59, v44, v61
    s_waitcnt vmcnt(10)
    v_lshlrev_b32 v60, 16, v108
    v_and_b32 v61, 0xffff0000, v108
    v_fmac_f32 v52, v45, v60
    v_fmac_f32 v53, v45, v61
    v_lshlrev_b32 v60, 16, v109
    v_and_b32 v61, 0xffff0000, v109
    v_fmac_f32 v54, v45, v60
    v_fmac_f32 v55, v45, v61
    v_lshlrev_b32 v60, 16, v110
    v_and_b32 v61, 0xffff0000, v110
    v_fmac_f32 v56, v45, v60
    v_fmac_f32 v57, v45, v61
    v_lshlrev_b32 v60, 16, v111
    v_and_b32 v61, 0xffff0000, v111
    v_fmac_f32 v58, v45, v60
    v_fmac_f32 v59, v45, v61
    s_waitcnt vmcnt(9)
    v_lshlrev_b32 v60, 16, v112
    v_and_b32 v61, 0xffff0000, v112
    v_fmac_f32 v52, v46, v60
    v_fmac_f32 v53, v46, v61
    v_lshlrev_b32 v60, 16, v113
    v_and_b32 v61, 0xffff0000, v113
    v_fmac_f32 v54, v46, v60
    v_fmac_f32 v55, v46, v61
    v_lshlrev_b32 v60, 16, v114
    v_and_b32 v61, 0xffff0000, v114
    v_fmac_f32 v56, v46, v60
    v_fmac_f32 v57, v46, v61
    v_lshlrev_b32 v60, 16, v115
    v_and_b32 v61, 0xffff0000, v115
    v_fmac_f32 v58, v46, v60
    v_fmac_f32 v59, v46, v61
    s_waitcnt vmcnt(8)
    v_lshlrev_b32 v60, 16, v116
    v_and_b32 v61, 0xffff0000, v116
    v_fmac_f32 v52, v47, v60
    v_fmac_f32 v53, v47, v61
    v_lshlrev_b32 v60, 16, v117
    v_and_b32 v61, 0xffff0000, v117
    v_fmac_f32 v54, v47, v60
    v_fmac_f32 v55, v47, v61
    v_lshlrev_b32 v60, 16, v118
    v_and_b32 v61, 0xffff0000, v118
    v_fmac_f32 v56, v47, v60
    v_fmac_f32 v57, v47, v61
    v_lshlrev_b32 v60, 16, v119
    v_and_b32 v61, 0xffff0000, v119
    v_fmac_f32 v58, v47, v60
    v_fmac_f32 v59, v47, v61
    s_waitcnt vmcnt(7)
    v_lshlrev_b32 v60, 16, v120
    v_and_b32 v61, 0xffff0000, v120
    v_fmac_f32 v52, v48, v60
    v_fmac_f32 v53, v48, v61
    v_lshlrev_b32 v60, 16, v121
    v_and_b32 v61, 0xffff0000, v121
    v_fmac_f32 v54, v48, v60
    v_fmac_f32 v55, v48, v61
    v_lshlrev_b32 v60, 16, v122
    v_and_b32 v61, 0xffff0000, v122
    v_fmac_f32 v56, v48, v60
    v_fmac_f32 v57, v48, v61
    v_lshlrev_b32 v60, 16, v123
    v_and_b32 v61, 0xffff0000, v123
    v_fmac_f32 v58, v48, v60
    v_fmac_f32 v59, v48, v61
    s_waitcnt vmcnt(6)
    v_lshlrev_b32 v60, 16, v124
    v_and_b32 v61, 0xffff0000, v124
    v_fmac_f32 v52, v49, v60
    v_fmac_f32 v53, v49, v61
    v_lshlrev_b32 v60, 16, v125
    v_and_b32 v61, 0xffff0000, v125
    v_fmac_f32 v54, v49, v60
    v_fmac_f32 v55, v49, v61
    v_lshlrev_b32 v60, 16, v126
    v_and_b32 v61, 0xffff0000, v126
    v_fmac_f32 v56, v49, v60
    v_fmac_f32 v57, v49, v61
    v_lshlrev_b32 v60, 16, v127
    v_and_b32 v61, 0xffff0000, v127
    v_fmac_f32 v58, v49, v60
    v_fmac_f32 v59, v49, v61
    s_waitcnt vmcnt(5)
    v_lshlrev_b32 v60, 16, v128
    v_and_b32 v61, 0xffff0000, v128
    v_fmac_f32 v52, v50, v60
    v_fmac_f32 v53, v50, v61
    v_lshlrev_b32 v60, 16, v129
    v_and_b32 v61, 0xffff0000, v129
    v_fmac_f32 v54, v50, v60
    v_fmac_f32 v55, v50, v61
    v_lshlrev_b32 v60, 16, v130
    v_and_b32 v61, 0xffff0000, v130
    v_fmac_f32 v56, v50, v60
    v_fmac_f32 v57, v50, v61
    v_lshlrev_b32 v60, 16, v131
    v_and_b32 v61, 0xffff0000, v131
    v_fmac_f32 v58, v50, v60
    v_fmac_f32 v59, v50, v61
    s_waitcnt vmcnt(4)
    v_lshlrev_b32 v60, 16, v132
    v_and_b32 v61, 0xffff0000, v132
    v_fmac_f32 v52, v51, v60
    v_fmac_f32 v53, v51, v61
    v_lshlrev_b32 v60, 16, v133
    v_and_b32 v61, 0xffff0000, v133
    v_fmac_f32 v54, v51, v60
    v_fmac_f32 v55, v51, v61
    v_lshlrev_b32 v60, 16, v134
    v_and_b32 v61, 0xffff0000, v134
    v_fmac_f32 v56, v51, v60
    v_fmac_f32 v57, v51, v61
    v_lshlrev_b32 v60, 16, v135
    v_and_b32 v61, 0xffff0000, v135
    v_fmac_f32 v58, v51, v60
    v_fmac_f32 v59, v51, v61
    s_nop 1
    v_add_f32_dpp v52, v52, v52 row_ror:8 row_mask:0xf bank_mask:0xf
    v_add_f32_dpp v53, v53, v53 row_ror:8 row_mask:0xf bank_mask:0xf
    v_add_f32_dpp v54, v54, v54 row_ror:8 row_mask:0xf bank_mask:0xf
    v_add_f32_dpp v55, v55, v55 row_ror:8 row_mask:0xf bank_mask:0xf
    v_add_f32_dpp v56, v56, v56 row_ror:8 row_mask:0xf bank_mask:0xf
    v_add_f32_dpp v57, v57, v57 row_ror:8 row_mask:0xf bank_mask:0xf
    v_add_f32_dpp v58, v58, v58 row_ror:8 row_mask:0xf bank_mask:0xf
    v_add_f32_dpp v59, v59, v59 row_ror:8 row_mask:0xf bank_mask:0xf
    v_mov_b32 v32, v52
    v_mov_b32 v33, v53
    v_mov_b32 v34, v54
    v_mov_b32 v35, v55
    v_mov_b32 v36, v56
    v_mov_b32 v37, v57
    v_mov_b32 v38, v58
    v_mov_b32 v39, v59
    s_nop 1
    v_permlane16_swap_b32 v52, v32
    v_permlane16_swap_b32 v53, v33
    v_permlane16_swap_b32 v54, v34
    v_permlane16_swap_b32 v55, v35
    v_permlane16_swap_b32 v56, v36
    v_permlane16_swap_b32 v57, v37
    v_permlane16_swap_b32 v58, v38
    v_permlane16_swap_b32 v59, v39
    s_nop 1
    v_add_f32 v52, v52, v32
    v_add_f32 v53, v53, v33
    v_add_f32 v54, v54, v34
    v_add_f32 v55, v55, v35
    v_add_f32 v56, v56, v36
    v_add_f32 v57, v57, v37
    v_add_f32 v58, v58, v38
    v_add_f32 v59, v59, v39
    v_mov_b32 v32, v52
    v_mov_b32 v33, v53
    v_mov_b32 v34, v54
    v_mov_b32 v35, v55
    v_mov_b32 v36, v56
    v_mov_b32 v37, v57
    v_mov_b32 v38, v58
    v_mov_b32 v39, v59
    s_nop 1
    v_permlane32_swap_b32 v52, v32
    v_permlane32_swap_b32 v53, v33
    v_permlane32_swap_b32 v54, v34
    v_permlane32_swap_b32 v55, v35
    v_permlane32_swap_b32 v56, v36
    v_permlane32_swap_b32 v57, v37
    v_permlane32_swap_b32 v58, v38
    v_permlane32_swap_b32 v59, v39
    s_nop 1
    v_add_f32 v52, v52, v32
    v_add_f32 v53, v53, v33
    v_add_f32 v54, v54, v34
    v_add_f32 v55, v55, v35
    v_add_f32 v56, v56, v36
    v_add_f32 v57, v57, v37
    v_add_f32 v58, v58, v38
    v_add_f32 v59, v59, v39
    s_mov_b32 s70, 0
    s_getreg_b32 s71, hwreg(HW_REG_XCC_ID, 0, 3)
    s_waitcnt vmcnt(0)
L_nonce:
    s_lshr_b64 s[84:85], s[84:85], 4
    s_andn2_b32 s84, s84, 7
    s_or_b32 s84, s84, s71
    s_xor_b32 s85, s85, 0x5a3c96e1
    s_xor_b32 s62, s84, s85
    v_mov_b32 v62, s84
    v_mov_b32 v30, s62
    s_sub_u32 s84, s84, 250
L_nonce_ok:
    v_mov_b32 v32, v52
    v_mov_b32 v33, v62
    v_mov_b32 v34, v53
    v_mov_b32 v35, v30
    v_mov_b32 v36, v54
    v_mov_b32 v37, v62
    v_mov_b32 v38, v55
    v_mov_b32 v39, v30
    v_mov_b32 v40, v56
    v_mov_b32 v41, v62
    v_mov_b32 v42, v57
    v_mov_b32 v43, v30
    v_mov_b32 v44, v58
    v_mov_b32 v45, v62
    v_mov_b32 v46, v59
    v_mov_b32 v47, v30
    v_lshlrev_b32 v60, 6, v2
    s_lshl_b32 s62, s2, 9
    s_mov_b64 exec, 0xff
    buffer_store_dwordx4 v[32:35], v60, s[20:23], s62 offen offset:0 sc1
    buffer_store_dwordx4 v[36:39], v60, s[20:23], s62 offen offset:16 sc1
    buffer_store_dwordx4 v[40:43], v60, s[20:23], s62 offen offset:32 sc1
    buffer_store_dwordx4 v[44:47], v60, s[20:23], s62 offen offset:48 sc1
    s_mov_b64 exec, -1
    s_lshr_b32 s62, s2, 4
    s_lshl_b32 s63, s62, 2
    s_lshl_b32 s62, s62, 13
    s_add_u32 s69, s62, 4096
    s_mov_b32 s70, 0
    s_add_u32 s71, s88, 0
    buffer_load_dwordx4 v[64:67], v3, s[12:15], s71 offen offset:0 nt
    buffer_load_dwordx4 v[68:71], v3, s[12:15], s71 offen offset:1024 nt
    s_mov_b64 exec, s[4:5]
    buffer_load_dwordx4 v[72:75], v3, s[12:15], s71 offen offset:2048 nt
    buffer_load_dwordx4 v[76:79], v3, s[12:15], s71 offen offset:3072 nt
    s_not_b64 exec, exec
    buffer_load_dwordx4 v[72:75], v3, s[12:15], s71 offen offset:2048 nt
    buffer_load_dwordx4 v[76:79], v3, s[12:15], s71 offen offset:3072 nt
    s_mov_b64 exec, -1
    s_add_u32 s71, s88, 4096
    buffer_load_dwordx4 v[80:83], v3, s[12:15], s71 offen offset:0 nt
    buffer_load_dwordx4 v[84:87], v3, s[12:15], s71 offen offset:1024 nt
    s_mov_b64 exec, s[4:5]
    buffer_load_dwordx4 v[88:91], v3, s[12:15], s71 offen offset:2048 nt
    buffer_load_dwordx4 v[92:95], v3, s[12:15], s71 offen offset:3072 nt
    s_not_b64 exec, exec
    buffer_load_dwordx4 v[88:91], v3, s[12:15], s71 offen offset:2048 nt
    buffer_load_dwordx4 v[92:95], v3, s[12:15], s71 offen offset:3072 nt
    s_mov_b64 exec, -1
L_pollQ:
    buffer_load_dwordx4 v[192:195], v6, s[20:23], s62 offen offset:0 sc1
    buffer_load_dwordx4 v[196:199], v6, s[20:23], s62 offen offset:1024 sc1
    buffer_load_dwordx4 v[200:203], v6, s[20:23], s62 offen offset:2048 sc1
    buffer_load_dwordx4 v[204:207], v6, s[20:23], s62 offen offset:3072 sc1
    buffer_load_dwordx4 v[208:211], v6, s[20:23], s69 offen offset:0 sc1
    buffer_load_dwordx4 v[212:215], v6, s[20:23], s69 offen offset:1024 sc1
    buffer_load_dwordx4 v[216:219], v6, s[20:23], s69 offen offset:2048 sc1
    buffer_load_dwordx4 v[220:223], v6, s[20:23], s69 offen offset:3072 sc1
    s_waitcnt vmcnt(0)
    v_xor_b32 v32, v193, v195
    v_subrev_u32 v40, s84, v193
    v_xor_b32 v33, v197, v199
    v_subrev_u32 v41, s84, v197
    v_xor_b32 v34, v201, v203
    v_subrev_u32 v42, s84, v201
    v_xor_b32 v35, v205, v207
    v_subrev_u32 v43, s84, v205
    v_xor_b32 v36, v209, v211
    v_subrev_u32 v44, s84, v209
    v_xor_b32 v37, v213, v215
    v_subrev_u32 v45, s84, v213
    v_xor_b32 v38, v217, v219
    v_subrev_u32 v46, s84, v217
    v_xor_b32 v39, v221, v223
    v_subrev_u32 v47, s84, v221
    v_min3_u32 v48, v32, v33, v34
    v_max3_u32 v49, v32, v33, v34
    v_max3_u32 v50, v40, v41, v42
    v_min3_u32 v48, v48, v35, v36
    v_max3_u32 v49, v49, v35, v36
    v_max3_u32 v50, v50, v43, v44
    v_min3_u32 v48, v48, v37, v38
    v_max3_u32 v49, v49, v37, v38
    v_max3_u32 v50, v50, v45, v46
    v_min_u32 v48, v48, v39
    v_max_u32 v49, v49, v39
    v_max_u32 v50, v50, v47
    v_xor_b32 v48, s85, v48
    v_xor_b32 v49, s85, v49
    v_lshrrev_b32 v50, 16, v50
    v_or3_b32 v60, v48, v49, v50
    v_cmp_ne_u32 vcc, 0, v60
    s_add_u32 s70, s70, 1
    s_cbranch_vccz L_pollQ_done
    s_cmp_lt_u32 s70, 20000
    s_cbranch_scc1 L_pollQ
L_pollQ_done:
    v_add_f32 v192, v192, v200
    v_add_f32 v208, v208, v216
    v_add_f32 v192, v192, v208
    v_add_f32 v194, v194, v202
    v_add_f32 v210, v210, v218
    v_add_f32 v194, v194, v210
    v_add_f32 v196, v196, v204
    v_add_f32 v212, v212, v220
    v_add_f32 v196, v196, v212
    v_add_f32 v198, v198, v206
    v_add_f32 v214, v214, v222
    v_add_f32 v198, v198, v214
    v_cvt_pk_bf16_f32 v40, v192, v194
    v_cvt_pk_bf16_f32 v41, v196, v198
    v_lshlrev_b32 v33, 2, v2
    v_mov_b32 v38, 1
    ds_write_b32 v33, v40 offset:5120
    ds_write_b32 v33, v41 offset:5376
    s_waitcnt lgkmcnt(0)
    ds_write_b32 v63, v38 offset:5632
L_skipq:
    s_add_u32 s62, s88, 8192
    buffer_load_dwordx4 v[96:99], v3, s[12:15], s62 offen offset:0 nt
    buffer_load_dwordx4 v[100:103], v3, s[12:15], s62 offen offset:1024 nt
    s_mov_b64 exec, s[4:5]
    buffer_load_dwordx4 v[104:107], v3, s[12:15], s62 offen offset:2048 nt
    buffer_load_dwordx4 v[108:111], v3, s[12:15], s62 offen offset:3072 nt
    s_not_b64 exec, exec
    buffer_load_dwordx4 v[104:107], v3, s[12:15], s62 offen offset:2048 nt
    buffer_load_dwordx4 v[108:111], v3, s[12:15], s62 offen offset:3072 nt
    s_mov_b64 exec, -1
    s_add_u32 s62, s88, 12288
    buffer_load_dwordx4 v[112:115], v3, s[12:15], s62 offen offset:0 nt
    buffer_load_dwordx4 v[116:119], v3, s[12:15], s62 offen offset:1024 nt
    s_mov_b64 exec, s[4:5]
    buffer_load_dwordx4 v[120:123], v3, s[12:15], s62 offen offset:2048 nt
    buffer_load_dwordx4 v[124:127], v3, s[12:15], s62 offen offset:3072 nt
    s_not_b64 exec, exec
    buffer_load_dwordx4 v[120:123], v3, s[12:15], s62 offen offset:2048 nt
    buffer_load_dwordx4 v[124:127], v3, s[12:15], s62 offen offset:3072 nt
    s_mov_b64 exec, -1
    s_add_u32 s62, s88, 16384
    buffer_load_dwordx4 v[128:131], v3, s[12:15], s62 offen offset:0 nt
    buffer_load_dwordx4 v[132:135], v3, s[12:15], s62 offen offset:1024 nt
    s_mov_b64 exec, s[4:5]
    buffer_load_dwordx4 v[136:139], v3, s[12:15], s62 offen offset:2048 nt
    buffer_load_dwordx4 v[140:143], v3, s[12:15], s62 offen offset:3072 nt
    s_not_b64 exec, exec
    buffer_load_dwordx4 v[136:139], v3, s[12:15], s62 offen offset:2048 nt
    buffer_load_dwordx4 v[140:143], v3, s[12:15], s62 offen offset:3072 nt
    s_mov_b64 exec, -1
    s_add_u32 s62, s88, 20480
    buffer_load_dwordx4 v[144:147], v3, s[12:15], s62 offen offset:0 nt
    buffer_load_dwordx4 v[148:151], v3, s[12:15], s62 offen offset:1024 nt
    s_mov_b64 exec, s[4:5]
    buffer_load_dwordx4 v[152:155], v3, s[12:15], s62 offen offset:2048 nt
    buffer_load_dwordx4 v[156:159], v3, s[12:15], s62 offen offset:3072 nt
    s_not_b64 exec, exec
    buffer_load_dwordx4 v[152:155], v3, s[12:15], s62 offen offset:2048 nt
    buffer_load_dwordx4 v[156:159], v3, s[12:15], s62 offen offset:3072 nt
    s_mov_b64 exec, -1
    s_add_u32 s62, s88, 24576
    buffer_load_dwordx4 v[160:163], v3, s[12:15], s62 offen offset:0 nt
    buffer_load_dwordx4 v[164:167], v3, s[12:15], s62 offen offset:1024 nt
    s_mov_b64 exec, s[4:5]
    buffer_load_dwordx4 v[168:171], v3, s[12:15], s62 offen offset:2048 nt
    buffer_load_dwordx4 v[172:175], v3, s[12:15], s62 offen offset:3072 nt
    s_not_b64 exec, exec
    buffer_load_dwordx4 v[168:171], v3, s[12:15], s62 offen offset:2048 nt
    buffer_load_dwordx4 v[172:175], v3, s[12:15], s62 offen offset:3072 nt
    s_mov_b64 exec, -1
    s_add_u32 s62, s88, 28672
    buffer_load_dwordx4 v[176:179], v3, s[12:15], s62 offen offset:0 nt
    buffer_load_dwordx4 v[180:183], v3, s[12:15], s62 offen offset:1024 nt
    s_mov_b64 exec, s[4:5]
    buffer_load_dwordx4 v[184:187], v3, s[12:15], s62 offen offset:2048 nt
    buffer_load_dwordx4 v[188:191], v3, s[12:15], s62 offen offset:3072 nt
    s_not_b64 exec, exec
    buffer_load_dwordx4 v[184:187], v3, s[12:15], s62 offen offset:2048 nt
    buffer_load_dwordx4 v[188:191], v3, s[12:15], s62 offen offset:3072 nt
    s_mov_b64 exec, -1
    v_and_b32 v32, 7, v193
    v_and_b32 v33, 7, v197
    v_lshl_or_b32 v32, v33, 4, v32
    v_and_b32 v33, 7, v201
    v_lshl_or_b32 v32, v33, 8, v32
    v_and_b32 v33, 7, v205
    v_lshl_or_b32 v32, v33, 12, v32
    v_and_b32 v33, 7, v209
    v_lshl_or_b32 v32, v33, 16, v32
    v_and_b32 v33, 7, v213
    v_lshl_or_b32 v32, v33, 20, v32
    v_and_b32 v33, 7, v217
    v_lshl_or_b32 v32, v33, 24, v32
    v_and_b32 v33, 7, v221
    v_lshl_or_b32 v32, v33, 28, v32
    v_lshrrev_b32 v33, 3, v2
    s_mov_b32 exec_lo, 1
    s_mov_b32 exec_hi, 1
    ds_write_b32 v33, v32 offset:5672
    s_mov_b64 exec, -1
    s_setprio 1
L_q_ok:
    v_and_b32 v200, 0xfffffdff, v3
    v_mov_b32 v192, 0
    v_mov_b32 v193, 0
    v_mov_b32 v194, 0
    v_mov_b32 v195, 0
    v_mov_b32 v196, 0
    v_mov_b32 v197, 0
    v_mov_b32 v198, 0
    v_mov_b32 v199, 0
    s_mov_b32 exec_lo, 0x00ff00ff
    s_mov_b32 exec_hi, 0x00ff00ff
    ds_read_b128 v[192:195], v200 offset:5120
    s_not_b64 exec, exec
    ds_read_b128 v[196:199], v200 offset:5120
    s_mov_b64 exec, -1
    s_mov_b32 s96, s88
    s_add_u32 s97, s88, 4096
    s_add_u32 s98, s88, 8192
    s_add_u32 s99, s88, 12288
    s_cmp_lt_u32 s3, 4
    s_cselect_b32 s63, 0, 0x40000000
    v_mov_b32 v50, 1
    s_mov_b32 s94, 17
    s_lshr_b32 s71, s2, 4
    s_mul_i32 s71, s71, 256
    s_add_u32 s71, s71, 131072
    v_mov_b32 v49, 0
    s_mov_b32 s64, 0x3db504f3
    s_mov_b32 s65, 0x3fb8aa3b
    s_mov_b32 s66, 0x05040100
    s_mov_b32 s67, 0x07060302
    s_mov_b32 s68, 0x41c00000
    s_mov_b32 s44, 0x0c0c0400
    s_mov_b32 s45, 0x04000c0c
    s_mov_b32 s46, 0xffffff00
    v_mov_b32 v224, 0
    v_mov_b32 v225, 0
    v_mov_b32 v226, 0
    v_mov_b32 v227, 0
    v_mov_b32 v228, 0
    v_mov_b32 v229, 0
    v_mov_b32 v230, 0
    v_mov_b32 v231, 0
    v_mov_b32 v232, 0
    v_mov_b32 v233, 0
    v_mov_b32 v234, 0
    v_mov_b32 v235, 0
    v_mov_b32 v236, 0
    v_mov_b32 v237, 0
    v_mov_b32 v238, 0
    v_mov_b32 v239, 0
    v_mov_b32 v8, 0x7149f2ca
    v_mov_b32 v9, 0x7149f2ca
    v_mov_b32 v10, 0
    v_mov_b32 v11, 0
    s_waitcnt vmcnt(42)
    s_mov_b64 exec, 1
    ds_add_u32 v49, v50 offset:5640
    s_mov_b64 exec, -1
    s_waitcnt lgkmcnt(0)
    s_or_b32 s72, s3, 0xff
    s_lshr_b32 s70, s3, 3
    s_mov_b32 s81, s70
    s_mov_b32 s73, s72
    s_mov_b32 s74, s70
    s_mov_b32 s75, s70
    s_mov_b32 s69, s70
    s_mov_b32 s92, s70
    s_mov_b32 s82, s70
    s_mov_b32 s83, s70
    s_mov_b32 s77, s70
    s_mov_b32 s78, s70
    s_mov_b32 s79, s70
    s_mov_b32 s96, 0x11111111
    s_mov_b32 s97, 0x11111111
    v_bfe_u32 v60, v2, 2, 1
    v_bfe_u32 v55, v2, 3, 1
    v_lshl_add_u32 v60, v60, 1, v55
    v_lshl_add_u32 v60, v60, 2, v5
    v_add_u32 v60, 98624, v60
    s_lshl_b32 s62, s3, 9
    v_add_u32 v208, s62, v60
    s_add_u32 s62, s62, 64
    v_add_u32 v209, s62, v60
    s_add_u32 s62, s62, 64
    v_add_u32 v210, s62, v60
    s_add_u32 s62, s62, 64
    v_add_u32 v211, s62, v60
    s_add_u32 s62, s62, 64
    v_add_u32 v212, s62, v60
    s_add_u32 s62, s62, 64
    v_add_u32 v213, s62, v60
    s_add_u32 s62, s62, 64
    v_add_u32 v214, s62, v60
    s_add_u32 s62, s62, 64
    v_add_u32 v215, s62, v60
    s_cmp_ge_u32 s63, 0x1000000
    s_cbranch_scc1 L_noiss0
    s_branch L_loop_entry
L_loop:
L_s0:
    s_lshl_b32 s72, s72, 1
    s_lshl_b32 s81, s81, 1
    s_cmp_lg_u32 s79, 0
    s_cbranch_scc1 L_issV0
    s_cmp_ge_u32 s63, 0x1000000
    s_cbranch_scc1 L_none0
    s_mov_b32 s77, s63
    s_mov_b32 s78, s83
    s_cmp_eq_u32 s82, 0
    s_cbranch_scc1 L_issK0
L_issV0:
    s_or_b32 s72, s72, 1
    s_or_b32 s81, s81, 1
    v_add_u32 v215, s78, v60
    buffer_load_dwordx4 v[176:179], v6, s[16:19], s77 offen offset:0 nt
    buffer_load_dwordx4 v[180:183], v6, s[16:19], s77 offen offset:1024 nt
    s_mov_b64 exec, s[6:7]
    buffer_load_dwordx4 v[184:187], v6, s[16:19], s77 offen offset:2048 nt
    buffer_load_dwordx4 v[188:191], v6, s[16:19], s77 offen offset:3072 nt
    s_not_b64 exec, exec
    buffer_load_dwordx4 v[184:187], v6, s[16:19], s77 offen offset:2048 nt
    buffer_load_dwordx4 v[188:191], v6, s[16:19], s77 offen offset:3072 nt
    s_mov_b64 exec, -1
    s_cmp_lg_u32 s79, 0
    s_mov_b32 s79, 0
    s_cbranch_scc1 L_noiss0
    s_branch L_tk0
L_issK0:
    s_or_b32 s72, s72, 1
    v_add_u32 v215, s78, v60
    buffer_load_dwordx4 v[176:179], v3, s[12:15], s77 offen offset:0 nt
    buffer_load_dwordx4 v[180:183], v3, s[12:15], s77 offen offset:1024 nt
    s_mov_b64 exec, s[4:5]
    buffer_load_dwordx4 v[184:187], v3, s[12:15], s77 offen offset:2048 nt
    buffer_load_dwordx4 v[188:191], v3, s[12:15], s77 offen offset:3072 nt
    s_not_b64 exec, exec
    buffer_load_dwordx4 v[184:187], v3, s[12:15], s77 offen offset:2048 nt
    buffer_load_dwordx4 v[188:191], v3, s[12:15], s77 offen offset:3072 nt
    s_mov_b64 exec, -1
    s_cmp_ge_u32 s69, 488
    s_cselect_b32 s79, 1, 0
L_tk0:
L_loop_entry:
    s_mov_b64 exec, 1
    ds_add_rtn_u32 v48, v49, v50 offset:5636
    s_mov_b64 exec, -1
    s_mov_b32 s63, 0x10000000
L_noiss0:
    ds_read_b32 v46, v208
    s_cmp_lg_u32 s63, 0x10000000
    s_cbranch_scc1 L_resx0
    s_waitcnt lgkmcnt(1)
    v_readfirstlane_b32 s69, v48
    s_nop 0
    s_sub_u32 s92, s69, 244
    s_cmp_lt_u32 s69, 244
    s_cselect_b32 s92, s69, s92
    s_cselect_b32 s82, 0, 1
    s_lshl_b32 s83, s92, 6
    s_lshl_b32 s63, s92, 12
    s_add_u32 s63, s63, s89
    s_cmp_ge_u32 s69, 488
    s_cbranch_scc1 L_pool0
L_res_done0:
    s_bitcmp1_b32 s72, 7
    s_cbranch_scc0 L_s1
    s_bitcmp1_b32 s81, 7
    s_cbranch_scc0 L_w0
    s_waitcnt lgkmcnt(0)
    v_cmp_eq_u32 vcc, -1, v46
    s_mov_b32 s75, 0
    s_cbranch_vccnz L_sw0
L_sok0:
    v_lshlrev_b32 v12, 16, v46
    v_and_b32 v13, 0xffff0000, v46
L_retry0:
    v_fma_f32 v20, v12, s65, v8
    v_fma_f32 v21, v13, s65, v8
    v_max_f32 v36, v20, v21
    v_cmp_lt_f32 vcc, s68, v36
    s_cbranch_vccnz L_rescale
    v_exp_f32 v20, v20
    v_exp_f32 v21, v21
    s_nop 0
    v_cvt_pk_bf16_f32 v29, v20, v21
    v_add_f32 v36, v20, v21
    v_add_f32 v10, v10, v36
    v_mov_b32_dpp v32, v29 row_newbcast:0 row_mask:0xf bank_mask:0xf
    v_mov_b32_dpp v33, v29 row_newbcast:8 row_mask:0xf bank_mask:0xf
    v_mov_b32_dpp v34, v29 row_newbcast:4 row_mask:0xf bank_mask:0xf
    v_mov_b32_dpp v35, v29 row_newbcast:12 row_mask:0xf bank_mask:0xf
L_w0:
    s_and_b32 s73, s72, 0x7f
    s_cmp_lg_u32 s73, 0x7f
    s_cbranch_scc1 L_slow0
    s_waitcnt vmcnt(42)
L_wok0:
    s_bitcmp1_b32 s81, 7
    s_cbranch_scc1 L_cV0
    v_mfma_f32_16x16x32_bf16 v[240:243], v[64:67], v[192:195], 0
    v_mfma_f32_16x16x32_bf16 v[244:247], v[68:71], v[192:195], 0
    v_mfma_f32_16x16x32_bf16 v[240:243], v[72:75], v[196:199], v[240:243]
    v_mfma_f32_16x16x32_bf16 v[244:247], v[76:79], v[196:199], v[244:247]
    s_nop 7
    s_nop 7
    v_mov_b32_dpp v12, v240 quad_perm:[0,0,0,0] row_mask:0xf bank_mask:0xf
    v_mov_b32_dpp v13, v244 quad_perm:[0,0,0,0] row_mask:0xf bank_mask:0xf
    v_add_f32_dpp v12, v241, v12 quad_perm:[1,1,1,1] row_mask:0xf bank_mask:0xf
    v_add_f32_dpp v13, v245, v13 quad_perm:[1,1,1,1] row_mask:0xf bank_mask:0xf
    v_add_f32_dpp v12, v242, v12 quad_perm:[2,2,2,2] row_mask:0xf bank_mask:0xf
    v_add_f32_dpp v13, v246, v13 quad_perm:[2,2,2,2] row_mask:0xf bank_mask:0xf
    v_add_f32_dpp v12, v243, v12 quad_perm:[3,3,3,3] row_mask:0xf bank_mask:0xf
    v_add_f32_dpp v13, v247, v13 quad_perm:[3,3,3,3] row_mask:0xf bank_mask:0xf
    v_cvt_pk_bf16_f32 v28, v12, v13
    v_lshlrev_b32 v12, 16, v28
    v_and_b32 v13, 0xffff0000, v28
    v_mul_f32 v12, s64, v12
    v_mul_f32 v13, s64, v13
    v_cvt_pk_bf16_f32 v28, v12, v13
    s_mov_b64 exec, s[96:97]
    ds_write_b32 v208, v28
    s_mov_b64 exec, -1
    s_branch L_s1
L_cV0:
    v_perm_b32 v38, v68, v64, s66
    v_perm_b32 v39, v68, v64, s67
    v_dot2_f32_bf16 v224, v38, v32, v224
    v_dot2_f32_bf16 v225, v39, v32, v225
    v_dot2_f32_bf16 v232, v38, v34, v232
    v_dot2_f32_bf16 v233, v39, v34, v233
    v_perm_b32 v40, v69, v65, s66
    v_perm_b32 v41, v69, v65, s67
    v_dot2_f32_bf16 v226, v40, v32, v226
    v_dot2_f32_bf16 v227, v41, v32, v227
    v_dot2_f32_bf16 v234, v40, v34, v234
    v_dot2_f32_bf16 v235, v41, v34, v235
    v_perm_b32 v38, v70, v66, s66
    v_perm_b32 v39, v70, v66, s67
    v_dot2_f32_bf16 v228, v38, v32, v228
    v_dot2_f32_bf16 v229, v39, v32, v229
    v_dot2_f32_bf16 v236, v38, v34, v236
    v_dot2_f32_bf16 v237, v39, v34, v237
    v_perm_b32 v40, v71, v67, s66
    v_perm_b32 v41, v71, v67, s67
    v_dot2_f32_bf16 v230, v40, v32, v230
    v_dot2_f32_bf16 v231, v41, v32, v231
    v_dot2_f32_bf16 v238, v40, v34, v238
    v_dot2_f32_bf16 v239, v41, v34, v239
    v_perm_b32 v38, v76, v72, s66
    v_perm_b32 v39, v76, v72, s67
    v_dot2_f32_bf16 v224, v38, v33, v224
    v_dot2_f32_bf16 v225, v39, v33, v225
    v_dot2_f32_bf16 v232, v38, v35, v232
    v_dot2_f32_bf16 v233, v39, v35, v233
    v_perm_b32 v40, v77, v73, s66
    v_perm_b32 v41, v77, v73, s67
    v_dot2_f32_bf16 v226, v40, v33, v226
    v_dot2_f32_bf16 v227, v41, v33, v227
    v_dot2_f32_bf16 v234, v40, v35, v234
    v_dot2_f32_bf16 v235, v41, v35, v235
    v_perm_b32 v38, v78, v74, s66
    v_perm_b32 v39, v78, v74, s67
    v_dot2_f32_bf16 v228, v38, v33, v228
    v_dot2_f32_bf16 v229, v39, v33, v229
    v_dot2_f32_bf16 v236, v38, v35, v236
    v_dot2_f32_bf16 v237, v39, v35, v237
    v_perm_b32 v40, v79, v75, s66
    v_perm_b32 v41, v79, v75, s67
    v_dot2_f32_bf16 v230, v40, v33, v230
    v_dot2_f32_bf16 v231, v41, v33, v231
    v_dot2_f32_bf16 v238, v40, v35, v238
    v_dot2_f32_bf16 v239, v41, v35, v239
L_s1:
    s_lshl_b32 s72, s72, 1
    s_lshl_b32 s81, s81, 1
    s_cmp_lg_u32 s79, 0
    s_cbranch_scc1 L_issV1
    s_cmp_ge_u32 s63, 0x1000000
    s_cbranch_scc1 L_none1
    s_mov_b32 s77, s63
    s_mov_b32 s78, s83
    s_cmp_eq_u32 s82, 0
    s_cbranch_scc1 L_issK1
L_issV1:
    s_or_b32 s72, s72, 1
    s_or_b32 s81, s81, 1
    v_add_u32 v208, s78, v60
    buffer_load_dwordx4 v[64:67], v6, s[16:19], s77 offen offset:0 nt
    buffer_load_dwordx4 v[68:71], v6, s[16:19], s77 offen offset:1024 nt
    s_mov_b64 exec, s[6:7]
    buffer_load_dwordx4 v[72:75], v6, s[16:19], s77 offen offset:2048 nt
    buffer_load_dwordx4 v[76:79], v6, s[16:19], s77 offen offset:3072 nt
    s_not_b64 exec, exec
    buffer_load_dwordx4 v[72:75], v6, s[16:19], s77 offen offset:2048 nt
    buffer_load_dwordx4 v[76:79], v6, s[16:19], s77 offen offset:3072 nt
    s_mov_b64 exec, -1
    s_cmp_lg_u32 s79, 0
    s_mov_b32 s79, 0
    s_cbranch_scc1 L_noiss1
    s_branch L_tk1
L_issK1:
    s_or_b32 s72, s72, 1
    v_add_u32 v208, s78, v60
    buffer_load_dwordx4 v[64:67], v3, s[12:15], s77 offen offset:0 nt
    buffer_load_dwordx4 v[68:71], v3, s[12:15], s77 offen offset:1024 nt
    s_mov_b64 exec, s[4:5]
    buffer_load_dwordx4 v[72:75], v3, s[12:15], s77 offen offset:2048 nt
    buffer_load_dwordx4 v[76:79], v3, s[12:15], s77 offen offset:3072 nt
    s_not_b64 exec, exec
    buffer_load_dwordx4 v[72:75], v3, s[12:15], s77 offen offset:2048 nt
    buffer_load_dwordx4 v[76:79], v3, s[12:15], s77 offen offset:3072 nt
    s_mov_b64 exec, -1
    s_cmp_ge_u32 s69, 488
    s_cselect_b32 s79, 1, 0
L_tk1:
    s_mov_b64 exec, 1
    ds_add_rtn_u32 v48, v49, v50 offset:5636
    s_mov_b64 exec, -1
    s_mov_b32 s63, 0x10000000
L_noiss1:
    ds_read_b32 v46, v209
    s_cmp_lg_u32 s63, 0x10000000
    s_cbranch_scc1 L_resx1
    s_waitcnt lgkmcnt(1)
    v_readfirstlane_b32 s69, v48
    s_nop 0
    s_sub_u32 s92, s69, 244
    s_cmp_lt_u32 s69, 244
    s_cselect_b32 s92, s69, s92
    s_cselect_b32 s82, 0, 1
    s_lshl_b32 s83, s92, 6
    s_lshl_b32 s63, s92, 12
    s_add_u32 s63, s63, s89
    s_cmp_ge_u32 s69, 488
    s_cbranch_scc1 L_pool1
L_res_done1:
    s_bitcmp1_b32 s72, 7
    s_cbranch_scc0 L_s2
    s_bitcmp1_b32 s81, 7
    s_cbranch_scc0 L_w1
    s_waitcnt lgkmcnt(0)
    v_cmp_eq_u32 vcc, -1, v46
    s_mov_b32 s75, 1
    s_cbranch_vccnz L_sw1
L_sok1:
    v_lshlrev_b32 v12, 16, v46
    v_and_b32 v13, 0xffff0000, v46
L_retry1:
    v_fma_f32 v20, v12, s65, v8
    v_fma_f32 v21, v13, s65, v8
    v_max_f32 v36, v20, v21
    v_cmp_lt_f32 vcc, s68, v36
    s_cbranch_vccnz L_rescale
    v_exp_f32 v20, v20
    v_exp_f32 v21, v21
    s_nop 0
    v_cvt_pk_bf16_f32 v29, v20, v21
    v_add_f32 v36, v20, v21
    v_add_f32 v10, v10, v36
    v_mov_b32_dpp v32, v29 row_newbcast:0 row_mask:0xf bank_mask:0xf
    v_mov_b32_dpp v33, v29 row_newbcast:8 row_mask:0xf bank_mask:0xf
    v_mov_b32_dpp v34, v29 row_newbcast:4 row_mask:0xf bank_mask:0xf
    v_mov_b32_dpp v35, v29 row_newbcast:12 row_mask:0xf bank_mask:0xf
L_w1:
    s_and_b32 s73, s72, 0x7f
    s_cmp_lg_u32 s73, 0x7f
    s_cbranch_scc1 L_slow1
    s_waitcnt vmcnt(42)
L_wok1:
    s_bitcmp1_b32 s81, 7
    s_cbranch_scc1 L_cV1
    v_mfma_f32_16x16x32_bf16 v[240:243], v[80:83], v[192:195], 0
    v_mfma_f32_16x16x32_bf16 v[244:247], v[84:87], v[192:195], 0
    v_mfma_f32_16x16x32_bf16 v[240:243], v[88:91], v[196:199], v[240:243]
    v_mfma_f32_16x16x32_bf16 v[244:247], v[92:95], v[196:199], v[244:247]
    s_nop 7
    s_nop 7
    v_mov_b32_dpp v12, v240 quad_perm:[0,0,0,0] row_mask:0xf bank_mask:0xf
    v_mov_b32_dpp v13, v244 quad_perm:[0,0,0,0] row_mask:0xf bank_mask:0xf
    v_add_f32_dpp v12, v241, v12 quad_perm:[1,1,1,1] row_mask:0xf bank_mask:0xf
    v_add_f32_dpp v13, v245, v13 quad_perm:[1,1,1,1] row_mask:0xf bank_mask:0xf
    v_add_f32_dpp v12, v242, v12 quad_perm:[2,2,2,2] row_mask:0xf bank_mask:0xf
    v_add_f32_dpp v13, v246, v13 quad_perm:[2,2,2,2] row_mask:0xf bank_mask:0xf
    v_add_f32_dpp v12, v243, v12 quad_perm:[3,3,3,3] row_mask:0xf bank_mask:0xf
    v_add_f32_dpp v13, v247, v13 quad_perm:[3,3,3,3] row_mask:0xf bank_mask:0xf
    v_cvt_pk_bf16_f32 v28, v12, v13
    v_lshlrev_b32 v12, 16, v28
    v_and_b32 v13, 0xffff0000, v28
    v_mul_f32 v12, s64, v12
    v_mul_f32 v13, s64, v13
    v_cvt_pk_bf16_f32 v28, v12, v13
    s_mov_b64 exec, s[96:97]
    ds_write_b32 v209, v28
    s_mov_b64 exec, -1
    s_branch L_s2
L_cV1:
    v_perm_b32 v38, v84, v80, s66
    v_perm_b32 v39, v84, v80, s67
    v_dot2_f32_bf16 v224, v38, v32, v224
    v_dot2_f32_bf16 v225, v39, v32, v225
    v_dot2_f32_bf16 v232, v38, v34, v232
    v_dot2_f32_bf16 v233, v39, v34, v233
    v_perm_b32 v40, v85, v81, s66
    v_perm_b32 v41, v85, v81, s67
    v_dot2_f32_bf16 v226, v40, v32, v226
    v_dot2_f32_bf16 v227, v41, v32, v227
    v_dot2_f32_bf16 v234, v40, v34, v234
    v_dot2_f32_bf16 v235, v41, v34, v235
    v_perm_b32 v38, v86, v82, s66
    v_perm_b32 v39, v86, v82, s67
    v_dot2_f32_bf16 v228, v38, v32, v228
    v_dot2_f32_bf16 v229, v39, v32, v229
    v_dot2_f32_bf16 v236, v38, v34, v236
    v_dot2_f32_bf16 v237, v39, v34, v237
    v_perm_b32 v40, v87, v83, s66
    v_perm_b32 v41, v87, v83, s67
    v_dot2_f32_bf16 v230, v40, v32, v230
    v_dot2_f32_bf16 v231, v41, v32, v231
    v_dot2_f32_bf16 v238, v40, v34, v238
    v_dot2_f32_bf16 v239, v41, v34, v239
    v_perm_b32 v38, v92, v88, s66
    v_perm_b32 v39, v92, v88, s67
    v_dot2_f32_bf16 v224, v38, v33, v224
    v_dot2_f32_bf16 v225, v39, v33, v225
    v_dot2_f32_bf16 v232, v38, v35, v232
    v_dot2_f32_bf16 v233, v39, v35, v233
    v_perm_b32 v40, v93, v89, s66
    v_perm_b32 v41, v93, v89, s67
    v_dot2_f32_bf16 v226, v40, v33, v226
    v_dot2_f32_bf16 v227, v41, v33, v227
    v_dot2_f32_bf16 v234, v40, v35, v234
    v_dot2_f32_bf16 v235, v41, v35, v235
    v_perm_b32 v38, v94, v90, s66
    v_perm_b32 v39, v94, v90, s67
    v_dot2_f32_bf16 v228, v38, v33, v228
    v_dot2_f32_bf16 v229, v39, v33, v229
    v_dot2_f32_bf16 v236, v38, v35, v236
    v_dot2_f32_bf16 v237, v39, v35, v237
    v_perm_b32 v40, v95, v91, s66
    v_perm_b32 v41, v95, v91, s67
    v_dot2_f32_bf16 v230, v40, v33, v230
    v_dot2_f32_bf16 v231, v41, v33, v231
    v_dot2_f32_bf16 v238, v40, v35, v238
    v_dot2_f32_bf16 v239, v41, v35, v239
L_s2:
    s_lshl_b32 s72, s72, 1
    s_lshl_b32 s81, s81, 1
    s_cmp_lg_u32 s79, 0
    s_cbranch_scc1 L_issV2
    s_cmp_ge_u32 s63, 0x1000000
    s_cbranch_scc1 L_none2
    s_mov_b32 s77, s63
    s_mov_b32 s78, s83
    s_cmp_eq_u32 s82, 0
    s_cbranch_scc1 L_issK2
L_issV2:
    s_or_b32 s72, s72, 1
    s_or_b32 s81, s81, 1
    v_add_u32 v209, s78, v60
    buffer_load_dwordx4 v[80:83], v6, s[16:19], s77 offen offset:0 nt
    buffer_load_dwordx4 v[84:87], v6, s[16:19], s77 offen offset:1024 nt
    s_mov_b64 exec, s[6:7]
    buffer_load_dwordx4 v[88:91], v6, s[16:19], s77 offen offset:2048 nt
    buffer_load_dwordx4 v[92:95], v6, s[16:19], s77 offen offset:3072 nt
    s_not_b64 exec, exec
    buffer_load_dwordx4 v[88:91], v6, s[16:19], s77 offen offset:2048 nt
    buffer_load_dwordx4 v[92:95], v6, s[16:19], s77 offen offset:3072 nt
    s_mov_b64 exec, -1
    s_cmp_lg_u32 s79, 0
    s_mov_b32 s79, 0
    s_cbranch_scc1 L_noiss2
    s_branch L_tk2
L_issK2:
    s_or_b32 s72, s72, 1
    v_add_u32 v209, s78, v60
    buffer_load_dwordx4 v[80:83], v3, s[12:15], s77 offen offset:0 nt
    buffer_load_dwordx4 v[84:87], v3, s[12:15], s77 offen offset:1024 nt
    s_mov_b64 exec, s[4:5]
    buffer_load_dwordx4 v[88:91], v3, s[12:15], s77 offen offset:2048 nt
    buffer_load_dwordx4 v[92:95], v3, s[12:15], s77 offen offset:3072 nt
    s_not_b64 exec, exec
    buffer_load_dwordx4 v[88:91], v3, s[12:15], s77 offen offset:2048 nt
    buffer_load_dwordx4 v[92:95], v3, s[12:15], s77 offen offset:3072 nt
    s_mov_b64 exec, -1
    s_cmp_ge_u32 s69, 488
    s_cselect_b32 s79, 1, 0
L_tk2:
    s_mov_b64 exec, 1
    ds_add_rtn_u32 v48, v49, v50 offset:5636
    s_mov_b64 exec, -1
    s_mov_b32 s63, 0x10000000
L_noiss2:
    ds_read_b32 v46, v210
    s_cmp_lg_u32 s63, 0x10000000
    s_cbranch_scc1 L_resx2
    s_waitcnt lgkmcnt(1)
    v_readfirstlane_b32 s69, v48
    s_nop 0
    s_sub_u32 s92, s69, 244
    s_cmp_lt_u32 s69, 244
    s_cselect_b32 s92, s69, s92
    s_cselect_b32 s82, 0, 1
    s_lshl_b32 s83, s92, 6
    s_lshl_b32 s63, s92, 12
    s_add_u32 s63, s63, s89
    s_cmp_ge_u32 s69, 488
    s_cbranch_scc1 L_pool2
L_res_done2:
    s_bitcmp1_b32 s72, 7
    s_cbranch_scc0 L_s3
    s_bitcmp1_b32 s81, 7
    s_cbranch_scc0 L_w2
    s_waitcnt lgkmcnt(0)
    v_cmp_eq_u32 vcc, -1, v46
    s_mov_b32 s75, 2
    s_cbranch_vccnz L_sw2
L_sok2:
    v_lshlrev_b32 v12, 16, v46
    v_and_b32 v13, 0xffff0000, v46
L_retry2:
    v_fma_f32 v20, v12, s65, v8
    v_fma_f32 v21, v13, s65, v8
    v_max_f32 v36, v20, v21
    v_cmp_lt_f32 vcc, s68, v36
    s_cbranch_vccnz L_rescale
    v_exp_f32 v20, v20
    v_exp_f32 v21, v21
    s_nop 0
    v_cvt_pk_bf16_f32 v29, v20, v21
    v_add_f32 v36, v20, v21
    v_add_f32 v10, v10, v36
    v_mov_b32_dpp v32, v29 row_newbcast:0 row_mask:0xf bank_mask:0xf
    v_mov_b32_dpp v33, v29 row_newbcast:8 row_mask:0xf bank_mask:0xf
    v_mov_b32_dpp v34, v29 row_newbcast:4 row_mask:0xf bank_mask:0xf
    v_mov_b32_dpp v35, v29 row_newbcast:12 row_mask:0xf bank_mask:0xf
L_w2:
    s_and_b32 s73, s72, 0x7f
    s_cmp_lg_u32 s73, 0x7f
    s_cbranch_scc1 L_slow2
    s_waitcnt vmcnt(42)
L_wok2:
    s_bitcmp1_b32 s81, 7
    s_cbranch_scc1 L_cV2
    v_mfma_f32_16x16x32_bf16 v[240:243], v[96:99], v[192:195], 0
    v_mfma_f32_16x16x32_bf16 v[244:247], v[100:103], v[192:195], 0
    v_mfma_f32_16x16x32_bf16 v[240:243], v[104:107], v[196:199], v[240:243]
    v_mfma_f32_16x16x32_bf16 v[244:247], v[108:111], v[196:199], v[244:247]
    s_nop 7
    s_nop 7
    v_mov_b32_dpp v12, v240 quad_perm:[0,0,0,0] row_mask:0xf bank_mask:0xf
    v_mov_b32_dpp v13, v244 quad_perm:[0,0,0,0] row_mask:0xf bank_mask:0xf
    v_add_f32_dpp v12, v241, v12 quad_perm:[1,1,1,1] row_mask:0xf bank_mask:0xf
    v_add_f32_dpp v13, v245, v13 quad_perm:[1,1,1,1] row_mask:0xf bank_mask:0xf
    v_add_f32_dpp v12, v242, v12 quad_perm:[2,2,2,2] row_mask:0xf bank_mask:0xf
    v_add_f32_dpp v13, v246, v13 quad_perm:[2,2,2,2] row_mask:0xf bank_mask:0xf
    v_add_f32_dpp v12, v243, v12 quad_perm:[3,3,3,3] row_mask:0xf bank_mask:0xf
    v_add_f32_dpp v13, v247, v13 quad_perm:[3,3,3,3] row_mask:0xf bank_mask:0xf
    v_cvt_pk_bf16_f32 v28, v12, v13
    v_lshlrev_b32 v12, 16, v28
    v_and_b32 v13, 0xffff0000, v28
    v_mul_f32 v12, s64, v12
    v_mul_f32 v13, s64, v13
    v_cvt_pk_bf16_f32 v28, v12, v13
    s_mov_b64 exec, s[96:97]
    ds_write_b32 v210, v28
    s_mov_b64 exec, -1
    s_branch L_s3
L_cV2:
    v_perm_b32 v38, v100, v96, s66
    v_perm_b32 v39, v100, v96, s67
    v_dot2_f32_bf16 v224, v38, v32, v224
    v_dot2_f32_bf16 v225, v39, v32, v225
    v_dot2_f32_bf16 v232, v38, v34, v232
    v_dot2_f32_bf16 v233, v39, v34, v233
    v_perm_b32 v40, v101, v97, s66
    v_perm_b32 v41, v101, v97, s67
    v_dot2_f32_bf16 v226, v40, v32, v226
    v_dot2_f32_bf16 v227, v41, v32, v227
    v_dot2_f32_bf16 v234, v40, v34, v234
    v_dot2_f32_bf16 v235, v41, v34, v235
    v_perm_b32 v38, v102, v98, s66
    v_perm_b32 v39, v102, v98, s67
    v_dot2_f32_bf16 v228, v38, v32, v228
    v_dot2_f32_bf16 v229, v39, v32, v229
    v_dot2_f32_bf16 v236, v38, v34, v236
    v_dot2_f32_bf16 v237, v39, v34, v237
    v_perm_b32 v40, v103, v99, s66
    v_perm_b32 v41, v103, v99, s67
    v_dot2_f32_bf16 v230, v40, v32, v230
    v_dot2_f32_bf16 v231, v41, v32, v231
    v_dot2_f32_bf16 v238, v40, v34, v238
    v_dot2_f32_bf16 v239, v41, v34, v239
    v_perm_b32 v38, v108, v104, s66
    v_perm_b32 v39, v108, v104, s67
    v_dot2_f32_bf16 v224, v38, v33, v224
    v_dot2_f32_bf16 v225, v39, v33, v225
    v_dot2_f32_bf16 v232, v38, v35, v232
    v_dot2_f32_bf16 v233, v39, v35, v233
    v_perm_b32 v40, v109, v105, s66
    v_perm_b32 v41, v109, v105, s67
    v_dot2_f32_bf16 v226, v40, v33, v226
    v_dot2_f32_bf16 v227, v41, v33, v227
    v_dot2_f32_bf16 v234, v40, v35, v234
    v_dot2_f32_bf16 v235, v41, v35, v235
    v_perm_b32 v38, v110, v106, s66
    v_perm_b32 v39, v110, v106, s67
    v_dot2_f32_bf16 v228, v38, v33, v228
    v_dot2_f32_bf16 v229, v39, v33, v229
    v_dot2_f32_bf16 v236, v38, v35, v236
    v_dot2_f32_bf16 v237, v39, v35, v237
    v_perm_b32 v40, v111, v107, s66
    v_perm_b32 v41, v111, v107, s67
    v_dot2_f32_bf16 v230, v40, v33, v230
    v_dot2_f32_bf16 v231, v41, v33, v231
    v_dot2_f32_bf16 v238, v40, v35, v238
    v_dot2_f32_bf16 v239, v41, v35, v239
L_s3:
    s_lshl_b32 s72, s72, 1
    s_lshl_b32 s81, s81, 1
    s_cmp_lg_u32 s79, 0
    s_cbranch_scc1 L_issV3
    s_cmp_ge_u32 s63, 0x1000000
    s_cbranch_scc1 L_none3
    s_mov_b32 s77, s63
    s_mov_b32 s78, s83
    s_cmp_eq_u32 s82, 0
    s_cbranch_scc1 L_issK3
L_issV3:
    s_or_b32 s72, s72, 1
    s_or_b32 s81, s81, 1
    v_add_u32 v210, s78, v60
    buffer_load_dwordx4 v[96:99], v6, s[16:19], s77 offen offset:0 nt
    buffer_load_dwordx4 v[100:103], v6, s[16:19], s77 offen offset:1024 nt
    s_mov_b64 exec, s[6:7]
    buffer_load_dwordx4 v[104:107], v6, s[16:19], s77 offen offset:2048 nt
    buffer_load_dwordx4 v[108:111], v6, s[16:19], s77 offen offset:3072 nt
    s_not_b64 exec, exec
    buffer_load_dwordx4 v[104:107], v6, s[16:19], s77 offen offset:2048 nt
    buffer_load_dwordx4 v[108:111], v6, s[16:19], s77 offen offset:3072 nt
    s_mov_b64 exec, -1
    s_cmp_lg_u32 s79, 0
    s_mov_b32 s79, 0
    s_cbranch_scc1 L_noiss3
    s_branch L_tk3
L_issK3:
    s_or_b32 s72, s72, 1
    v_add_u32 v210, s78, v60
    buffer_load_dwordx4 v[96:99], v3, s[12:15], s77 offen offset:0 nt
    buffer_load_dwordx4 v[100:103], v3, s[12:15], s77 offen offset:1024 nt
    s_mov_b64 exec, s[4:5]
    buffer_load_dwordx4 v[104:107], v3, s[12:15], s77 offen offset:2048 nt
    buffer_load_dwordx4 v[108:111], v3, s[12:15], s77 offen offset:3072 nt
    s_not_b64 exec, exec
    buffer_load_dwordx4 v[104:107], v3, s[12:15], s77 offen offset:2048 nt
    buffer_load_dwordx4 v[108:111], v3, s[12:15], s77 offen offset:3072 nt
    s_mov_b64 exec, -1
    s_cmp_ge_u32 s69, 488
    s_cselect_b32 s79, 1, 0
L_tk3:
    s_mov_b64 exec, 1
    ds_add_rtn_u32 v48, v49, v50 offset:5636
    s_mov_b64 exec, -1
    s_mov_b32 s63, 0x10000000
L_noiss3:
    ds_read_b32 v46, v211
    s_cmp_lg_u32 s63, 0x10000000
    s_cbranch_scc1 L_resx3
    s_waitcnt lgkmcnt(1)
    v_readfirstlane_b32 s69, v48
    s_nop 0
    s_sub_u32 s92, s69, 244
    s_cmp_lt_u32 s69, 244
    s_cselect_b32 s92, s69, s92
    s_cselect_b32 s82, 0, 1
    s_lshl_b32 s83, s92, 6
    s_lshl_b32 s63, s92, 12
    s_add_u32 s63, s63, s89
    s_cmp_ge_u32 s69, 488
    s_cbranch_scc1 L_pool3
L_res_done3:
    s_bitcmp1_b32 s72, 7
    s_cbranch_scc0 L_s4
    s_bitcmp1_b32 s81, 7
    s_cbranch_scc0 L_w3
    s_waitcnt lgkmcnt(0)
    v_cmp_eq_u32 vcc, -1, v46
    s_mov_b32 s75, 3
    s_cbranch_vccnz L_sw3
L_sok3:
    v_lshlrev_b32 v12, 16, v46
    v_and_b32 v13, 0xffff0000, v46
L_retry3:
    v_fma_f32 v20, v12, s65, v8
    v_fma_f32 v21, v13, s65, v8
    v_max_f32 v36, v20, v21
    v_cmp_lt_f32 vcc, s68, v36
    s_cbranch_vccnz L_rescale
    v_exp_f32 v20, v20
    v_exp_f32 v21, v21
    s_nop 0
    v_cvt_pk_bf16_f32 v29, v20, v21
    v_add_f32 v36, v20, v21
    v_add_f32 v10, v10, v36
    v_mov_b32_dpp v32, v29 row_newbcast:0 row_mask:0xf bank_mask:0xf
    v_mov_b32_dpp v33, v29 row_newbcast:8 row_mask:0xf bank_mask:0xf
    v_mov_b32_dpp v34, v29 row_newbcast:4 row_mask:0xf bank_mask:0xf
    v_mov_b32_dpp v35, v29 row_newbcast:12 row_mask:0xf bank_mask:0xf
L_w3:
    s_and_b32 s73, s72, 0x7f
    s_cmp_lg_u32 s73, 0x7f
    s_cbranch_scc1 L_slow3
    s_waitcnt vmcnt(42)
L_wok3:
    s_bitcmp1_b32 s81, 7
    s_cbranch_scc1 L_cV3
    v_mfma_f32_16x16x32_bf16 v[240:243], v[112:115], v[192:195], 0
    v_mfma_f32_16x16x32_bf16 v[244:247], v[116:119], v[192:195], 0
    v_mfma_f32_16x16x32_bf16 v[240:243], v[120:123], v[196:199], v[240:243]
    v_mfma_f32_16x16x32_bf16 v[244:247], v[124:127], v[196:199], v[244:247]
    s_nop 7
    s_nop 7
    v_mov_b32_dpp v12, v240 quad_perm:[0,0,0,0] row_mask:0xf bank_mask:0xf
    v_mov_b32_dpp v13, v244 quad_perm:[0,0,0,0] row_mask:0xf bank_mask:0xf
    v_add_f32_dpp v12, v241, v12 quad_perm:[1,1,1,1] row_mask:0xf bank_mask:0xf
    v_add_f32_dpp v13, v245, v13 quad_perm:[1,1,1,1] row_mask:0xf bank_mask:0xf
    v_add_f32_dpp v12, v242, v12 quad_perm:[2,2,2,2] row_mask:0xf bank_mask:0xf
    v_add_f32_dpp v13, v246, v13 quad_perm:[2,2,2,2] row_mask:0xf bank_mask:0xf
    v_add_f32_dpp v12, v243, v12 quad_perm:[3,3,3,3] row_mask:0xf bank_mask:0xf
    v_add_f32_dpp v13, v247, v13 quad_perm:[3,3,3,3] row_mask:0xf bank_mask:0xf
    v_cvt_pk_bf16_f32 v28, v12, v13
    v_lshlrev_b32 v12, 16, v28
    v_and_b32 v13, 0xffff0000, v28
    v_mul_f32 v12, s64, v12
    v_mul_f32 v13, s64, v13
    v_cvt_pk_bf16_f32 v28, v12, v13
    s_mov_b64 exec, s[96:97]
    ds_write_b32 v211, v28
    s_mov_b64 exec, -1
    s_branch L_s4
L_cV3:
    v_perm_b32 v38, v116, v112, s66
    v_perm_b32 v39, v116, v112, s67
    v_dot2_f32_bf16 v224, v38, v32, v224
    v_dot2_f32_bf16 v225, v39, v32, v225
    v_dot2_f32_bf16 v232, v38, v34, v232
    v_dot2_f32_bf16 v233, v39, v34, v233
    v_perm_b32 v40, v117, v113, s66
    v_perm_b32 v41, v117, v113, s67
    v_dot2_f32_bf16 v226, v40, v32, v226
    v_dot2_f32_bf16 v227, v41, v32, v227
    v_dot2_f32_bf16 v234, v40, v34, v234
    v_dot2_f32_bf16 v235, v41, v34, v235
    v_perm_b32 v38, v118, v114, s66
    v_perm_b32 v39, v118, v114, s67
    v_dot2_f32_bf16 v228, v38, v32, v228
    v_dot2_f32_bf16 v229, v39, v32, v229
    v_dot2_f32_bf16 v236, v38, v34, v236
    v_dot2_f32_bf16 v237, v39, v34, v237
    v_perm_b32 v40, v119, v115, s66
    v_perm_b32 v41, v119, v115, s67
    v_dot2_f32_bf16 v230, v40, v32, v230
    v_dot2_f32_bf16 v231, v41, v32, v231
    v_dot2_f32_bf16 v238, v40, v34, v238
    v_dot2_f32_bf16 v239, v41, v34, v239
    v_perm_b32 v38, v124, v120, s66
    v_perm_b32 v39, v124, v120, s67
    v_dot2_f32_bf16 v224, v38, v33, v224
    v_dot2_f32_bf16 v225, v39, v33, v225
    v_dot2_f32_bf16 v232, v38, v35, v232
    v_dot2_f32_bf16 v233, v39, v35, v233
    v_perm_b32 v40, v125, v121, s66
    v_perm_b32 v41, v125, v121, s67
    v_dot2_f32_bf16 v226, v40, v33, v226
    v_dot2_f32_bf16 v227, v41, v33, v227
    v_dot2_f32_bf16 v234, v40, v35, v234
    v_dot2_f32_bf16 v235, v41, v35, v235
    v_perm_b32 v38, v126, v122, s66
    v_perm_b32 v39, v126, v122, s67
    v_dot2_f32_bf16 v228, v38, v33, v228
    v_dot2_f32_bf16 v229, v39, v33, v229
    v_dot2_f32_bf16 v236, v38, v35, v236
    v_dot2_f32_bf16 v237, v39, v35, v237
    v_perm_b32 v40, v127, v123, s66
    v_perm_b32 v41, v127, v123, s67
    v_dot2_f32_bf16 v230, v40, v33, v230
    v_dot2_f32_bf16 v231, v41, v33, v231
    v_dot2_f32_bf16 v238, v40, v35, v238
    v_dot2_f32_bf16 v239, v41, v35, v239
L_s4:
    s_lshl_b32 s72, s72, 1
    s_lshl_b32 s81, s81, 1
    s_cmp_lg_u32 s79, 0
    s_cbranch_scc1 L_issV4
    s_cmp_ge_u32 s63, 0x1000000
    s_cbranch_scc1 L_none4
    s_mov_b32 s77, s63
    s_mov_b32 s78, s83
    s_cmp_eq_u32 s82, 0
    s_cbranch_scc1 L_issK4
L_issV4:
    s_or_b32 s72, s72, 1
    s_or_b32 s81, s81, 1
    v_add_u32 v211, s78, v60
    buffer_load_dwordx4 v[112:115], v6, s[16:19], s77 offen offset:0 nt
    buffer_load_dwordx4 v[116:119], v6, s[16:19], s77 offen offset:1024 nt
    s_mov_b64 exec, s[6:7]
    buffer_load_dwordx4 v[120:123], v6, s[16:19], s77 offen offset:2048 nt
    buffer_load_dwordx4 v[124:127], v6, s[16:19], s77 offen offset:3072 nt
    s_not_b64 exec, exec
    buffer_load_dwordx4 v[120:123], v6, s[16:19], s77 offen offset:2048 nt
    buffer_load_dwordx4 v[124:127], v6, s[16:19], s77 offen offset:3072 nt
    s_mov_b64 exec, -1
    s_cmp_lg_u32 s79, 0
    s_mov_b32 s79, 0
    s_cbranch_scc1 L_noiss4
    s_branch L_tk4
L_issK4:
    s_or_b32 s72, s72, 1
    v_add_u32 v211, s78, v60
    buffer_load_dwordx4 v[112:115], v3, s[12:15], s77 offen offset:0 nt
    buffer_load_dwordx4 v[116:119], v3, s[12:15], s77 offen offset:1024 nt
    s_mov_b64 exec, s[4:5]
    buffer_load_dwordx4 v[120:123], v3, s[12:15], s77 offen offset:2048 nt
    buffer_load_dwordx4 v[124:127], v3, s[12:15], s77 offen offset:3072 nt
    s_not_b64 exec, exec
    buffer_load_dwordx4 v[120:123], v3, s[12:15], s77 offen offset:2048 nt
    buffer_load_dwordx4 v[124:127], v3, s[12:15], s77 offen offset:3072 nt
    s_mov_b64 exec, -1
    s_cmp_ge_u32 s69, 488
    s_cselect_b32 s79, 1, 0
L_tk4:
    s_mov_b64 exec, 1
    ds_add_rtn_u32 v48, v49, v50 offset:5636
    s_mov_b64 exec, -1
    s_mov_b32 s63, 0x10000000
L_noiss4:
    ds_read_b32 v46, v212
    s_cmp_lg_u32 s63, 0x10000000
    s_cbranch_scc1 L_resx4
    s_waitcnt lgkmcnt(1)
    v_readfirstlane_b32 s69, v48
    s_nop 0
    s_sub_u32 s92, s69, 244
    s_cmp_lt_u32 s69, 244
    s_cselect_b32 s92, s69, s92
    s_cselect_b32 s82, 0, 1
    s_lshl_b32 s83, s92, 6
    s_lshl_b32 s63, s92, 12
    s_add_u32 s63, s63, s89
    s_cmp_ge_u32 s69, 488
    s_cbranch_scc1 L_pool4
L_res_done4:
    s_bitcmp1_b32 s72, 7
    s_cbranch_scc0 L_s5
    s_bitcmp1_b32 s81, 7
    s_cbranch_scc0 L_w4
    s_waitcnt lgkmcnt(0)
    v_cmp_eq_u32 vcc, -1, v46
    s_mov_b32 s75, 4
    s_cbranch_vccnz L_sw4
L_sok4:
    v_lshlrev_b32 v12, 16, v46
    v_and_b32 v13, 0xffff0000, v46
L_retry4:
    v_fma_f32 v20, v12, s65, v8
    v_fma_f32 v21, v13, s65, v8
    v_max_f32 v36, v20, v21
    v_cmp_lt_f32 vcc, s68, v36
    s_cbranch_vccnz L_rescale
    v_exp_f32 v20, v20
    v_exp_f32 v21, v21
    s_nop 0
    v_cvt_pk_bf16_f32 v29, v20, v21
    v_add_f32 v36, v20, v21
    v_add_f32 v10, v10, v36
    v_mov_b32_dpp v32, v29 row_newbcast:0 row_mask:0xf bank_mask:0xf
    v_mov_b32_dpp v33, v29 row_newbcast:8 row_mask:0xf bank_mask:0xf
    v_mov_b32_dpp v34, v29 row_newbcast:4 row_mask:0xf bank_mask:0xf
    v_mov_b32_dpp v35, v29 row_newbcast:12 row_mask:0xf bank_mask:0xf
L_w4:
    s_and_b32 s73, s72, 0x7f
    s_cmp_lg_u32 s73, 0x7f
    s_cbranch_scc1 L_slow4
    s_waitcnt vmcnt(42)
L_wok4:
    s_bitcmp1_b32 s81, 7
    s_cbranch_scc1 L_cV4
    v_mfma_f32_16x16x32_bf16 v[240:243], v[128:131], v[192:195], 0
    v_mfma_f32_16x16x32_bf16 v[244:247], v[132:135], v[192:195], 0
    v_mfma_f32_16x16x32_bf16 v[240:243], v[136:139], v[196:199], v[240:243]
    v_mfma_f32_16x16x32_bf16 v[244:247], v[140:143], v[196:199], v[244:247]
    s_nop 7
    s_nop 7
    v_mov_b32_dpp v12, v240 quad_perm:[0,0,0,0] row_mask:0xf bank_mask:0xf
    v_mov_b32_dpp v13, v244 quad_perm:[0,0,0,0] row_mask:0xf bank_mask:0xf
    v_add_f32_dpp v12, v241, v12 quad_perm:[1,1,1,1] row_mask:0xf bank_mask:0xf
    v_add_f32_dpp v13, v245, v13 quad_perm:[1,1,1,1] row_mask:0xf bank_mask:0xf
    v_add_f32_dpp v12, v242, v12 quad_perm:[2,2,2,2] row_mask:0xf bank_mask:0xf
    v_add_f32_dpp v13, v246, v13 quad_perm:[2,2,2,2] row_mask:0xf bank_mask:0xf
    v_add_f32_dpp v12, v243, v12 quad_perm:[3,3,3,3] row_mask:0xf bank_mask:0xf
    v_add_f32_dpp v13, v247, v13 quad_perm:[3,3,3,3] row_mask:0xf bank_mask:0xf
    v_cvt_pk_bf16_f32 v28, v12, v13
    v_lshlrev_b32 v12, 16, v28
    v_and_b32 v13, 0xffff0000, v28
    v_mul_f32 v12, s64, v12
    v_mul_f32 v13, s64, v13
    v_cvt_pk_bf16_f32 v28, v12, v13
    s_mov_b64 exec, s[96:97]
    ds_write_b32 v212, v28
    s_mov_b64 exec, -1
    s_branch L_s5
L_cV4:
    v_perm_b32 v38, v132, v128, s66
    v_perm_b32 v39, v132, v128, s67
    v_dot2_f32_bf16 v224, v38, v32, v224
    v_dot2_f32_bf16 v225, v39, v32, v225
    v_dot2_f32_bf16 v232, v38, v34, v232
    v_dot2_f32_bf16 v233, v39, v34, v233
    v_perm_b32 v40, v133, v129, s66
    v_perm_b32 v41, v133, v129, s67
    v_dot2_f32_bf16 v226, v40, v32, v226
    v_dot2_f32_bf16 v227, v41, v32, v227
    v_dot2_f32_bf16 v234, v40, v34, v234
    v_dot2_f32_bf16 v235, v41, v34, v235
    v_perm_b32 v38, v134, v130, s66
    v_perm_b32 v39, v134, v130, s67
    v_dot2_f32_bf16 v228, v38, v32, v228
    v_dot2_f32_bf16 v229, v39, v32, v229
    v_dot2_f32_bf16 v236, v38, v34, v236
    v_dot2_f32_bf16 v237, v39, v34, v237
    v_perm_b32 v40, v135, v131, s66
    v_perm_b32 v41, v135, v131, s67
    v_dot2_f32_bf16 v230, v40, v32, v230
    v_dot2_f32_bf16 v231, v41, v32, v231
    v_dot2_f32_bf16 v238, v40, v34, v238
    v_dot2_f32_bf16 v239, v41, v34, v239
    v_perm_b32 v38, v140, v136, s66
    v_perm_b32 v39, v140, v136, s67
    v_dot2_f32_bf16 v224, v38, v33, v224
    v_dot2_f32_bf16 v225, v39, v33, v225
    v_dot2_f32_bf16 v232, v38, v35, v232
    v_dot2_f32_bf16 v233, v39, v35, v233
    v_perm_b32 v40, v141, v137, s66
    v_perm_b32 v41, v141, v137, s67
    v_dot2_f32_bf16 v226, v40, v33, v226
    v_dot2_f32_bf16 v227, v41, v33, v227
    v_dot2_f32_bf16 v234, v40, v35, v234
    v_dot2_f32_bf16 v235, v41, v35, v235
    v_perm_b32 v38, v142, v138, s66
    v_perm_b32 v39, v142, v138, s67
    v_dot2_f32_bf16 v228, v38, v33, v228
    v_dot2_f32_bf16 v229, v39, v33, v229
    v_dot2_f32_bf16 v236, v38, v35, v236
    v_dot2_f32_bf16 v237, v39, v35, v237
    v_perm_b32 v40, v143, v139, s66
    v_perm_b32 v41, v143, v139, s67
    v_dot2_f32_bf16 v230, v40, v33, v230
    v_dot2_f32_bf16 v231, v41, v33, v231
    v_dot2_f32_bf16 v238, v40, v35, v238
    v_dot2_f32_bf16 v239, v41, v35, v239
L_s5:
    s_lshl_b32 s72, s72, 1
    s_lshl_b32 s81, s81, 1
    s_cmp_lg_u32 s79, 0
    s_cbranch_scc1 L_issV5
    s_cmp_ge_u32 s63, 0x1000000
    s_cbranch_scc1 L_none5
    s_mov_b32 s77, s63
    s_mov_b32 s78, s83
    s_cmp_eq_u32 s82, 0
    s_cbranch_scc1 L_issK5
L_issV5:
    s_or_b32 s72, s72, 1
    s_or_b32 s81, s81, 1
    v_add_u32 v212, s78, v60
    buffer_load_dwordx4 v[128:131], v6, s[16:19], s77 offen offset:0 nt
    buffer_load_dwordx4 v[132:135], v6, s[16:19], s77 offen offset:1024 nt
    s_mov_b64 exec, s[6:7]
    buffer_load_dwordx4 v[136:139], v6, s[16:19], s77 offen offset:2048 nt
    buffer_load_dwordx4 v[140:143], v6, s[16:19], s77 offen offset:3072 nt
    s_not_b64 exec, exec
    buffer_load_dwordx4 v[136:139], v6, s[16:19], s77 offen offset:2048 nt
    buffer_load_dwordx4 v[140:143], v6, s[16:19], s77 offen offset:3072 nt
    s_mov_b64 exec, -1
    s_cmp_lg_u32 s79, 0
    s_mov_b32 s79, 0
    s_cbranch_scc1 L_noiss5
    s_branch L_tk5
L_issK5:
    s_or_b32 s72, s72, 1
    v_add_u32 v212, s78, v60
    buffer_load_dwordx4 v[128:131], v3, s[12:15], s77 offen offset:0 nt
    buffer_load_dwordx4 v[132:135], v3, s[12:15], s77 offen offset:1024 nt
    s_mov_b64 exec, s[4:5]
    buffer_load_dwordx4 v[136:139], v3, s[12:15], s77 offen offset:2048 nt
    buffer_load_dwordx4 v[140:143], v3, s[12:15], s77 offen offset:3072 nt
    s_not_b64 exec, exec
    buffer_load_dwordx4 v[136:139], v3, s[12:15], s77 offen offset:2048 nt
    buffer_load_dwordx4 v[140:143], v3, s[12:15], s77 offen offset:3072 nt
    s_mov_b64 exec, -1
    s_cmp_ge_u32 s69, 488
    s_cselect_b32 s79, 1, 0
L_tk5:
    s_mov_b64 exec, 1
    ds_add_rtn_u32 v48, v49, v50 offset:5636
    s_mov_b64 exec, -1
    s_mov_b32 s63, 0x10000000
L_noiss5:
    ds_read_b32 v46, v213
    s_cmp_lg_u32 s63, 0x10000000
    s_cbranch_scc1 L_resx5
    s_waitcnt lgkmcnt(1)
    v_readfirstlane_b32 s69, v48
    s_nop 0
    s_sub_u32 s92, s69, 244
    s_cmp_lt_u32 s69, 244
    s_cselect_b32 s92, s69, s92
    s_cselect_b32 s82, 0, 1
    s_lshl_b32 s83, s92, 6
    s_lshl_b32 s63, s92, 12
    s_add_u32 s63, s63, s89
    s_cmp_ge_u32 s69, 488
    s_cbranch_scc1 L_pool5
L_res_done5:
    s_bitcmp1_b32 s72, 7
    s_cbranch_scc0 L_s6
    s_bitcmp1_b32 s81, 7
    s_cbranch_scc0 L_w5
    s_waitcnt lgkmcnt(0)
    v_cmp_eq_u32 vcc, -1, v46
    s_mov_b32 s75, 5
    s_cbranch_vccnz L_sw5
L_sok5:
    v_lshlrev_b32 v12, 16, v46
    v_and_b32 v13, 0xffff0000, v46
L_retry5:
    v_fma_f32 v20, v12, s65, v8
    v_fma_f32 v21, v13, s65, v8
    v_max_f32 v36, v20, v21
    v_cmp_lt_f32 vcc, s68, v36
    s_cbranch_vccnz L_rescale
    v_exp_f32 v20, v20
    v_exp_f32 v21, v21
    s_nop 0
    v_cvt_pk_bf16_f32 v29, v20, v21
    v_add_f32 v36, v20, v21
    v_add_f32 v10, v10, v36
    v_mov_b32_dpp v32, v29 row_newbcast:0 row_mask:0xf bank_mask:0xf
    v_mov_b32_dpp v33, v29 row_newbcast:8 row_mask:0xf bank_mask:0xf
    v_mov_b32_dpp v34, v29 row_newbcast:4 row_mask:0xf bank_mask:0xf
    v_mov_b32_dpp v35, v29 row_newbcast:12 row_mask:0xf bank_mask:0xf
L_w5:
    s_and_b32 s73, s72, 0x7f
    s_cmp_lg_u32 s73, 0x7f
    s_cbranch_scc1 L_slow5
    s_waitcnt vmcnt(42)
L_wok5:
    s_bitcmp1_b32 s81, 7
    s_cbranch_scc1 L_cV5
    v_mfma_f32_16x16x32_bf16 v[240:243], v[144:147], v[192:195], 0
    v_mfma_f32_16x16x32_bf16 v[244:247], v[148:151], v[192:195], 0
    v_mfma_f32_16x16x32_bf16 v[240:243], v[152:155], v[196:199], v[240:243]
    v_mfma_f32_16x16x32_bf16 v[244:247], v[156:159], v[196:199], v[244:247]
    s_nop 7
    s_nop 7
    v_mov_b32_dpp v12, v240 quad_perm:[0,0,0,0] row_mask:0xf bank_mask:0xf
    v_mov_b32_dpp v13, v244 quad_perm:[0,0,0,0] row_mask:0xf bank_mask:0xf
    v_add_f32_dpp v12, v241, v12 quad_perm:[1,1,1,1] row_mask:0xf bank_mask:0xf
    v_add_f32_dpp v13, v245, v13 quad_perm:[1,1,1,1] row_mask:0xf bank_mask:0xf
    v_add_f32_dpp v12, v242, v12 quad_perm:[2,2,2,2] row_mask:0xf bank_mask:0xf
    v_add_f32_dpp v13, v246, v13 quad_perm:[2,2,2,2] row_mask:0xf bank_mask:0xf
    v_add_f32_dpp v12, v243, v12 quad_perm:[3,3,3,3] row_mask:0xf bank_mask:0xf
    v_add_f32_dpp v13, v247, v13 quad_perm:[3,3,3,3] row_mask:0xf bank_mask:0xf
    v_cvt_pk_bf16_f32 v28, v12, v13
    v_lshlrev_b32 v12, 16, v28
    v_and_b32 v13, 0xffff0000, v28
    v_mul_f32 v12, s64, v12
    v_mul_f32 v13, s64, v13
    v_cvt_pk_bf16_f32 v28, v12, v13
    s_mov_b64 exec, s[96:97]
    ds_write_b32 v213, v28
    s_mov_b64 exec, -1
    s_branch L_s6
L_cV5:
    v_perm_b32 v38, v148, v144, s66
    v_perm_b32 v39, v148, v144, s67
    v_dot2_f32_bf16 v224, v38, v32, v224
    v_dot2_f32_bf16 v225, v39, v32, v225
    v_dot2_f32_bf16 v232, v38, v34, v232
    v_dot2_f32_bf16 v233, v39, v34, v233
    v_perm_b32 v40, v149, v145, s66
    v_perm_b32 v41, v149, v145, s67
    v_dot2_f32_bf16 v226, v40, v32, v226
    v_dot2_f32_bf16 v227, v41, v32, v227
    v_dot2_f32_bf16 v234, v40, v34, v234
    v_dot2_f32_bf16 v235, v41, v34, v235
    v_perm_b32 v38, v150, v146, s66
    v_perm_b32 v39, v150, v146, s67
    v_dot2_f32_bf16 v228, v38, v32, v228
    v_dot2_f32_bf16 v229, v39, v32, v229
    v_dot2_f32_bf16 v236, v38, v34, v236
    v_dot2_f32_bf16 v237, v39, v34, v237
    v_perm_b32 v40, v151, v147, s66
    v_perm_b32 v41, v151, v147, s67
    v_dot2_f32_bf16 v230, v40, v32, v230
    v_dot2_f32_bf16 v231, v41, v32, v231
    v_dot2_f32_bf16 v238, v40, v34, v238
    v_dot2_f32_bf16 v239, v41, v34, v239
    v_perm_b32 v38, v156, v152, s66
    v_perm_b32 v39, v156, v152, s67
    v_dot2_f32_bf16 v224, v38, v33, v224
    v_dot2_f32_bf16 v225, v39, v33, v225
    v_dot2_f32_bf16 v232, v38, v35, v232
    v_dot2_f32_bf16 v233, v39, v35, v233
    v_perm_b32 v40, v157, v153, s66
    v_perm_b32 v41, v157, v153, s67
    v_dot2_f32_bf16 v226, v40, v33, v226
    v_dot2_f32_bf16 v227, v41, v33, v227
    v_dot2_f32_bf16 v234, v40, v35, v234
    v_dot2_f32_bf16 v235, v41, v35, v235
    v_perm_b32 v38, v158, v154, s66
    v_perm_b32 v39, v158, v154, s67
    v_dot2_f32_bf16 v228, v38, v33, v228
    v_dot2_f32_bf16 v229, v39, v33, v229
    v_dot2_f32_bf16 v236, v38, v35, v236
    v_dot2_f32_bf16 v237, v39, v35, v237
    v_perm_b32 v40, v159, v155, s66
    v_perm_b32 v41, v159, v155, s67
    v_dot2_f32_bf16 v230, v40, v33, v230
    v_dot2_f32_bf16 v231, v41, v33, v231
    v_dot2_f32_bf16 v238, v40, v35, v238
    v_dot2_f32_bf16 v239, v41, v35, v239
L_s6:
    s_lshl_b32 s72, s72, 1
    s_lshl_b32 s81, s81, 1
    s_cmp_lg_u32 s79, 0
    s_cbranch_scc1 L_issV6
    s_cmp_ge_u32 s63, 0x1000000
    s_cbranch_scc1 L_none6
    s_mov_b32 s77, s63
    s_mov_b32 s78, s83
    s_cmp_eq_u32 s82, 0
    s_cbranch_scc1 L_issK6
L_issV6:
    s_or_b32 s72, s72, 1
    s_or_b32 s81, s81, 1
    v_add_u32 v213, s78, v60
    buffer_load_dwordx4 v[144:147], v6, s[16:19], s77 offen offset:0 nt
    buffer_load_dwordx4 v[148:151], v6, s[16:19], s77 offen offset:1024 nt
    s_mov_b64 exec, s[6:7]
    buffer_load_dwordx4 v[152:155], v6, s[16:19], s77 offen offset:2048 nt
    buffer_load_dwordx4 v[156:159], v6, s[16:19], s77 offen offset:3072 nt
    s_not_b64 exec, exec
    buffer_load_dwordx4 v[152:155], v6, s[16:19], s77 offen offset:2048 nt
    buffer_load_dwordx4 v[156:159], v6, s[16:19], s77 offen offset:3072 nt
    s_mov_b64 exec, -1
    s_cmp_lg_u32 s79, 0
    s_mov_b32 s79, 0
    s_cbranch_scc1 L_noiss6
    s_branch L_tk6
L_issK6:
    s_or_b32 s72, s72, 1
    v_add_u32 v213, s78, v60
    buffer_load_dwordx4 v[144:147], v3, s[12:15], s77 offen offset:0 nt
    buffer_load_dwordx4 v[148:151], v3, s[12:15], s77 offen offset:1024 nt
    s_mov_b64 exec, s[4:5]
    buffer_load_dwordx4 v[152:155], v3, s[12:15], s77 offen offset:2048 nt
    buffer_load_dwordx4 v[156:159], v3, s[12:15], s77 offen offset:3072 nt
    s_not_b64 exec, exec
    buffer_load_dwordx4 v[152:155], v3, s[12:15], s77 offen offset:2048 nt
    buffer_load_dwordx4 v[156:159], v3, s[12:15], s77 offen offset:3072 nt
    s_mov_b64 exec, -1
    s_cmp_ge_u32 s69, 488
    s_cselect_b32 s79, 1, 0
L_tk6:
    s_mov_b64 exec, 1
    ds_add_rtn_u32 v48, v49, v50 offset:5636
    s_mov_b64 exec, -1
    s_mov_b32 s63, 0x10000000
L_noiss6:
    ds_read_b32 v46, v214
    s_cmp_lg_u32 s63, 0x10000000
    s_cbranch_scc1 L_resx6
    s_waitcnt lgkmcnt(1)
    v_readfirstlane_b32 s69, v48
    s_nop 0
    s_sub_u32 s92, s69, 244
    s_cmp_lt_u32 s69, 244
    s_cselect_b32 s92, s69, s92
    s_cselect_b32 s82, 0, 1
    s_lshl_b32 s83, s92, 6
    s_lshl_b32 s63, s92, 12
    s_add_u32 s63, s63, s89
    s_cmp_ge_u32 s69, 488
    s_cbranch_scc1 L_pool6
L_res_done6:
    s_bitcmp1_b32 s72, 7
    s_cbranch_scc0 L_s7
    s_bitcmp1_b32 s81, 7
    s_cbranch_scc0 L_w6
    s_waitcnt lgkmcnt(0)
    v_cmp_eq_u32 vcc, -1, v46
    s_mov_b32 s75, 6
    s_cbranch_vccnz L_sw6
L_sok6:
    v_lshlrev_b32 v12, 16, v46
    v_and_b32 v13, 0xffff0000, v46
L_retry6:
    v_fma_f32 v20, v12, s65, v8
    v_fma_f32 v21, v13, s65, v8
    v_max_f32 v36, v20, v21
    v_cmp_lt_f32 vcc, s68, v36
    s_cbranch_vccnz L_rescale
    v_exp_f32 v20, v20
    v_exp_f32 v21, v21
    s_nop 0
    v_cvt_pk_bf16_f32 v29, v20, v21
    v_add_f32 v36, v20, v21
    v_add_f32 v10, v10, v36
    v_mov_b32_dpp v32, v29 row_newbcast:0 row_mask:0xf bank_mask:0xf
    v_mov_b32_dpp v33, v29 row_newbcast:8 row_mask:0xf bank_mask:0xf
    v_mov_b32_dpp v34, v29 row_newbcast:4 row_mask:0xf bank_mask:0xf
    v_mov_b32_dpp v35, v29 row_newbcast:12 row_mask:0xf bank_mask:0xf
L_w6:
    s_and_b32 s73, s72, 0x7f
    s_cmp_lg_u32 s73, 0x7f
    s_cbranch_scc1 L_slow6
    s_waitcnt vmcnt(42)
L_wok6:
    s_bitcmp1_b32 s81, 7
    s_cbranch_scc1 L_cV6
    v_mfma_f32_16x16x32_bf16 v[240:243], v[160:163], v[192:195], 0
    v_mfma_f32_16x16x32_bf16 v[244:247], v[164:167], v[192:195], 0
    v_mfma_f32_16x16x32_bf16 v[240:243], v[168:171], v[196:199], v[240:243]
    v_mfma_f32_16x16x32_bf16 v[244:247], v[172:175], v[196:199], v[244:247]
    s_nop 7
    s_nop 7
    v_mov_b32_dpp v12, v240 quad_perm:[0,0,0,0] row_mask:0xf bank_mask:0xf
    v_mov_b32_dpp v13, v244 quad_perm:[0,0,0,0] row_mask:0xf bank_mask:0xf
    v_add_f32_dpp v12, v241, v12 quad_perm:[1,1,1,1] row_mask:0xf bank_mask:0xf
    v_add_f32_dpp v13, v245, v13 quad_perm:[1,1,1,1] row_mask:0xf bank_mask:0xf
    v_add_f32_dpp v12, v242, v12 quad_perm:[2,2,2,2] row_mask:0xf bank_mask:0xf
    v_add_f32_dpp v13, v246, v13 quad_perm:[2,2,2,2] row_mask:0xf bank_mask:0xf
    v_add_f32_dpp v12, v243, v12 quad_perm:[3,3,3,3] row_mask:0xf bank_mask:0xf
    v_add_f32_dpp v13, v247, v13 quad_perm:[3,3,3,3] row_mask:0xf bank_mask:0xf
    v_cvt_pk_bf16_f32 v28, v12, v13
    v_lshlrev_b32 v12, 16, v28
    v_and_b32 v13, 0xffff0000, v28
    v_mul_f32 v12, s64, v12
    v_mul_f32 v13, s64, v13
    v_cvt_pk_bf16_f32 v28, v12, v13
    s_mov_b64 exec, s[96:97]
    ds_write_b32 v214, v28
    s_mov_b64 exec, -1
    s_branch L_s7
L_cV6:
    v_perm_b32 v38, v164, v160, s66
    v_perm_b32 v39, v164, v160, s67
    v_dot2_f32_bf16 v224, v38, v32, v224
    v_dot2_f32_bf16 v225, v39, v32, v225
    v_dot2_f32_bf16 v232, v38, v34, v232
    v_dot2_f32_bf16 v233, v39, v34, v233
    v_perm_b32 v40, v165, v161, s66
    v_perm_b32 v41, v165, v161, s67
    v_dot2_f32_bf16 v226, v40, v32, v226
    v_dot2_f32_bf16 v227, v41, v32, v227
    v_dot2_f32_bf16 v234, v40, v34, v234
    v_dot2_f32_bf16 v235, v41, v34, v235
    v_perm_b32 v38, v166, v162, s66
    v_perm_b32 v39, v166, v162, s67
    v_dot2_f32_bf16 v228, v38, v32, v228
    v_dot2_f32_bf16 v229, v39, v32, v229
    v_dot2_f32_bf16 v236, v38, v34, v236
    v_dot2_f32_bf16 v237, v39, v34, v237
    v_perm_b32 v40, v167, v163, s66
    v_perm_b32 v41, v167, v163, s67
    v_dot2_f32_bf16 v230, v40, v32, v230
    v_dot2_f32_bf16 v231, v41, v32, v231
    v_dot2_f32_bf16 v238, v40, v34, v238
    v_dot2_f32_bf16 v239, v41, v34, v239
    v_perm_b32 v38, v172, v168, s66
    v_perm_b32 v39, v172, v168, s67
    v_dot2_f32_bf16 v224, v38, v33, v224
    v_dot2_f32_bf16 v225, v39, v33, v225
    v_dot2_f32_bf16 v232, v38, v35, v232
    v_dot2_f32_bf16 v233, v39, v35, v233
    v_perm_b32 v40, v173, v169, s66
    v_perm_b32 v41, v173, v169, s67
    v_dot2_f32_bf16 v226, v40, v33, v226
    v_dot2_f32_bf16 v227, v41, v33, v227
    v_dot2_f32_bf16 v234, v40, v35, v234
    v_dot2_f32_bf16 v235, v41, v35, v235
    v_perm_b32 v38, v174, v170, s66
    v_perm_b32 v39, v174, v170, s67
    v_dot2_f32_bf16 v228, v38, v33, v228
    v_dot2_f32_bf16 v229, v39, v33, v229
    v_dot2_f32_bf16 v236, v38, v35, v236
    v_dot2_f32_bf16 v237, v39, v35, v237
    v_perm_b32 v40, v175, v171, s66
    v_perm_b32 v41, v175, v171, s67
    v_dot2_f32_bf16 v230, v40, v33, v230
    v_dot2_f32_bf16 v231, v41, v33, v231
    v_dot2_f32_bf16 v238, v40, v35, v238
    v_dot2_f32_bf16 v239, v41, v35, v239
L_s7:
    s_lshl_b32 s72, s72, 1
    s_lshl_b32 s81, s81, 1
    s_cmp_lg_u32 s79, 0
    s_cbranch_scc1 L_issV7
    s_cmp_ge_u32 s63, 0x1000000
    s_cbranch_scc1 L_none7
    s_mov_b32 s77, s63
    s_mov_b32 s78, s83
    s_cmp_eq_u32 s82, 0
    s_cbranch_scc1 L_issK7
L_issV7:
    s_or_b32 s72, s72, 1
    s_or_b32 s81, s81, 1
    v_add_u32 v214, s78, v60
    buffer_load_dwordx4 v[160:163], v6, s[16:19], s77 offen offset:0 nt
    buffer_load_dwordx4 v[164:167], v6, s[16:19], s77 offen offset:1024 nt
    s_mov_b64 exec, s[6:7]
    buffer_load_dwordx4 v[168:171], v6, s[16:19], s77 offen offset:2048 nt
    buffer_load_dwordx4 v[172:175], v6, s[16:19], s77 offen offset:3072 nt
    s_not_b64 exec, exec
    buffer_load_dwordx4 v[168:171], v6, s[16:19], s77 offen offset:2048 nt
    buffer_load_dwordx4 v[172:175], v6, s[16:19], s77 offen offset:3072 nt
    s_mov_b64 exec, -1
    s_cmp_lg_u32 s79, 0
    s_mov_b32 s79, 0
    s_cbranch_scc1 L_noiss7
    s_branch L_tk7
L_issK7:
    s_or_b32 s72, s72, 1
    v_add_u32 v214, s78, v60
    buffer_load_dwordx4 v[160:163], v3, s[12:15], s77 offen offset:0 nt
    buffer_load_dwordx4 v[164:167], v3, s[12:15], s77 offen offset:1024 nt
    s_mov_b64 exec, s[4:5]
    buffer_load_dwordx4 v[168:171], v3, s[12:15], s77 offen offset:2048 nt
    buffer_load_dwordx4 v[172:175], v3, s[12:15], s77 offen offset:3072 nt
    s_not_b64 exec, exec
    buffer_load_dwordx4 v[168:171], v3, s[12:15], s77 offen offset:2048 nt
    buffer_load_dwordx4 v[172:175], v3, s[12:15], s77 offen offset:3072 nt
    s_mov_b64 exec, -1
    s_cmp_ge_u32 s69, 488
    s_cselect_b32 s79, 1, 0
L_tk7:
    s_mov_b64 exec, 1
    ds_add_rtn_u32 v48, v49, v50 offset:5636
    s_mov_b64 exec, -1
    s_mov_b32 s63, 0x10000000
L_noiss7:
    ds_read_b32 v46, v215
    s_cmp_lg_u32 s63, 0x10000000
    s_cbranch_scc1 L_resx7
    s_waitcnt lgkmcnt(1)
    v_readfirstlane_b32 s69, v48
    s_nop 0
    s_sub_u32 s92, s69, 244
    s_cmp_lt_u32 s69, 244
    s_cselect_b32 s92, s69, s92
    s_cselect_b32 s82, 0, 1
    s_lshl_b32 s83, s92, 6
    s_lshl_b32 s63, s92, 12
    s_add_u32 s63, s63, s89
    s_cmp_ge_u32 s69, 488
    s_cbranch_scc1 L_pool7
L_res_done7:
    s_bitcmp1_b32 s72, 7
    s_cbranch_scc0 L_s0
    s_bitcmp1_b32 s81, 7
    s_cbranch_scc0 L_w7
    s_waitcnt lgkmcnt(0)
    v_cmp_eq_u32 vcc, -1, v46
    s_mov_b32 s75, 7
    s_cbranch_vccnz L_sw7
L_sok7:
    v_lshlrev_b32 v12, 16, v46
    v_and_b32 v13, 0xffff0000, v46
L_retry7:
    v_fma_f32 v20, v12, s65, v8
    v_fma_f32 v21, v13, s65, v8
    v_max_f32 v36, v20, v21
    v_cmp_lt_f32 vcc, s68, v36
    s_cbranch_vccnz L_rescale
    v_exp_f32 v20, v20
    v_exp_f32 v21, v21
    s_nop 0
    v_cvt_pk_bf16_f32 v29, v20, v21
    v_add_f32 v36, v20, v21
    v_add_f32 v10, v10, v36
    v_mov_b32_dpp v32, v29 row_newbcast:0 row_mask:0xf bank_mask:0xf
    v_mov_b32_dpp v33, v29 row_newbcast:8 row_mask:0xf bank_mask:0xf
    v_mov_b32_dpp v34, v29 row_newbcast:4 row_mask:0xf bank_mask:0xf
    v_mov_b32_dpp v35, v29 row_newbcast:12 row_mask:0xf bank_mask:0xf
L_w7:
    s_and_b32 s73, s72, 0x7f
    s_cmp_lg_u32 s73, 0x7f
    s_cbranch_scc1 L_slow7
    s_waitcnt vmcnt(42)
L_wok7:
    s_bitcmp1_b32 s81, 7
    s_cbranch_scc1 L_cV7
    v_mfma_f32_16x16x32_bf16 v[240:243], v[176:179], v[192:195], 0
    v_mfma_f32_16x16x32_bf16 v[244:247], v[180:183], v[192:195], 0
    v_mfma_f32_16x16x32_bf16 v[240:243], v[184:187], v[196:199], v[240:243]
    v_mfma_f32_16x16x32_bf16 v[244:247], v[188:191], v[196:199], v[244:247]
    s_nop 7
    s_nop 7
    v_mov_b32_dpp v12, v240 quad_perm:[0,0,0,0] row_mask:0xf bank_mask:0xf
    v_mov_b32_dpp v13, v244 quad_perm:[0,0,0,0] row_mask:0xf bank_mask:0xf
    v_add_f32_dpp v12, v241, v12 quad_perm:[1,1,1,1] row_mask:0xf bank_mask:0xf
    v_add_f32_dpp v13, v245, v13 quad_perm:[1,1,1,1] row_mask:0xf bank_mask:0xf
    v_add_f32_dpp v12, v242, v12 quad_perm:[2,2,2,2] row_mask:0xf bank_mask:0xf
    v_add_f32_dpp v13, v246, v13 quad_perm:[2,2,2,2] row_mask:0xf bank_mask:0xf
    v_add_f32_dpp v12, v243, v12 quad_perm:[3,3,3,3] row_mask:0xf bank_mask:0xf
    v_add_f32_dpp v13, v247, v13 quad_perm:[3,3,3,3] row_mask:0xf bank_mask:0xf
    v_cvt_pk_bf16_f32 v28, v12, v13
    v_lshlrev_b32 v12, 16, v28
    v_and_b32 v13, 0xffff0000, v28
    v_mul_f32 v12, s64, v12
    v_mul_f32 v13, s64, v13
    v_cvt_pk_bf16_f32 v28, v12, v13
    s_mov_b64 exec, s[96:97]
    ds_write_b32 v215, v28
    s_mov_b64 exec, -1
    s_branch L_s0
L_cV7:
    v_perm_b32 v38, v180, v176, s66
    v_perm_b32 v39, v180, v176, s67
    v_dot2_f32_bf16 v224, v38, v32, v224
    v_dot2_f32_bf16 v225, v39, v32, v225
    v_dot2_f32_bf16 v232, v38, v34, v232
    v_dot2_f32_bf16 v233, v39, v34, v233
    v_perm_b32 v40, v181, v177, s66
    v_perm_b32 v41, v181, v177, s67
    v_dot2_f32_bf16 v226, v40, v32, v226
    v_dot2_f32_bf16 v227, v41, v32, v227
    v_dot2_f32_bf16 v234, v40, v34, v234
    v_dot2_f32_bf16 v235, v41, v34, v235
    v_perm_b32 v38, v182, v178, s66
    v_perm_b32 v39, v182, v178, s67
    v_dot2_f32_bf16 v228, v38, v32, v228
    v_dot2_f32_bf16 v229, v39, v32, v229
    v_dot2_f32_bf16 v236, v38, v34, v236
    v_dot2_f32_bf16 v237, v39, v34, v237
    v_perm_b32 v40, v183, v179, s66
    v_perm_b32 v41, v183, v179, s67
    v_dot2_f32_bf16 v230, v40, v32, v230
    v_dot2_f32_bf16 v231, v41, v32, v231
    v_dot2_f32_bf16 v238, v40, v34, v238
    v_dot2_f32_bf16 v239, v41, v34, v239
    v_perm_b32 v38, v188, v184, s66
    v_perm_b32 v39, v188, v184, s67
    v_dot2_f32_bf16 v224, v38, v33, v224
    v_dot2_f32_bf16 v225, v39, v33, v225
    v_dot2_f32_bf16 v232, v38, v35, v232
    v_dot2_f32_bf16 v233, v39, v35, v233
    v_perm_b32 v40, v189, v185, s66
    v_perm_b32 v41, v189, v185, s67
    v_dot2_f32_bf16 v226, v40, v33, v226
    v_dot2_f32_bf16 v227, v41, v33, v227
    v_dot2_f32_bf16 v234, v40, v35, v234
    v_dot2_f32_bf16 v235, v41, v35, v235
    v_perm_b32 v38, v190, v186, s66
    v_perm_b32 v39, v190, v186, s67
    v_dot2_f32_bf16 v228, v38, v33, v228
    v_dot2_f32_bf16 v229, v39, v33, v229
    v_dot2_f32_bf16 v236, v38, v35, v236
    v_dot2_f32_bf16 v237, v39, v35, v237
    v_perm_b32 v40, v191, v187, s66
    v_perm_b32 v41, v191, v187, s67
    v_dot2_f32_bf16 v230, v40, v33, v230
    v_dot2_f32_bf16 v231, v41, v33, v231
    v_dot2_f32_bf16 v238, v40, v35, v238
    v_dot2_f32_bf16 v239, v41, v35, v239
    s_branch L_s0
L_none0:
    s_and_b32 s73, s72, 0xff
    s_cbranch_scc1 L_noiss0
    s_cmp_ge_u32 s63, 0x40000000
    s_cbranch_scc1 L_exit
    s_add_u32 s70, s70, 1
    s_cmp_lt_u32 s70, 4194304
    s_cbranch_scc1 L_noiss0
    s_branch L_exit
L_sw0:
    ds_read_b32 v46, v208
    s_add_u32 s70, s70, 1
    s_cmp_ge_u32 s70, 4194304
    s_cbranch_scc1 L_sok0
    s_waitcnt lgkmcnt(0)
    v_cmp_eq_u32 vcc, -1, v46
    s_cbranch_vccnz L_sw0
    s_branch L_sok0
L_resx0:
    s_bitcmp1_b32 s63, 29
    s_cbranch_scc0 L_res_done0
L_pool0:
    s_sub_u32 s92, s69, 488
    s_lshl_b32 s83, s3, 6
    s_add_u32 s83, s83, 16384
    s_mov_b32 s82, 0
    s_andn2_b32 s92, s92, 1
    s_lshl_b32 s92, s92, 1
    v_mov_b32 v51, s92
    ds_read_b32 v48, v51 offset:14144
    s_waitcnt lgkmcnt(0)
    v_readfirstlane_b32 s63, v48
    s_nop 0
    s_sub_u32 s63, s63, 1
    s_cselect_b32 s63, 0x20000000, s63
    s_and_b32 s92, s69, 1
    s_lshl_b32 s92, s92, 12
    s_add_u32 s63, s63, s92
    s_branch L_res_done0
L_slow0:
    s_bcnt1_i32_b32 s74, s73
    s_cmp_ge_u32 s74, 4
    s_cbranch_scc1 L_slow0_4
    s_cmp_ge_u32 s74, 2
    s_cbranch_scc1 L_slow0_2
    s_cmp_eq_u32 s74, 1
    s_cbranch_scc1 L_slow0_1
    s_waitcnt vmcnt(0)
    s_branch L_wok0
L_slow0_1:
    s_waitcnt vmcnt(6)
    s_branch L_wok0
L_slow0_2:
    s_waitcnt vmcnt(18)
    s_cmp_eq_u32 s74, 3
    s_cbranch_scc1 L_wok0
    s_waitcnt vmcnt(12)
    s_branch L_wok0
L_slow0_4:
    s_waitcnt vmcnt(36)
    s_cmp_eq_u32 s74, 6
    s_cbranch_scc1 L_wok0
    s_waitcnt vmcnt(30)
    s_cmp_eq_u32 s74, 5
    s_cbranch_scc1 L_wok0
    s_waitcnt vmcnt(24)
    s_branch L_wok0
L_none1:
    s_and_b32 s73, s72, 0xff
    s_cbranch_scc1 L_noiss1
    s_cmp_ge_u32 s63, 0x40000000
    s_cbranch_scc1 L_exit
    s_add_u32 s70, s70, 1
    s_cmp_lt_u32 s70, 4194304
    s_cbranch_scc1 L_noiss1
    s_branch L_exit
L_sw1:
    ds_read_b32 v46, v209
    s_add_u32 s70, s70, 1
    s_cmp_ge_u32 s70, 4194304
    s_cbranch_scc1 L_sok1
    s_waitcnt lgkmcnt(0)
    v_cmp_eq_u32 vcc, -1, v46
    s_cbranch_vccnz L_sw1
    s_branch L_sok1
L_resx1:
    s_bitcmp1_b32 s63, 29
    s_cbranch_scc0 L_res_done1
L_pool1:
    s_sub_u32 s92, s69, 488
    s_lshl_b32 s83, s3, 6
    s_add_u32 s83, s83, 16384
    s_mov_b32 s82, 0
    s_andn2_b32 s92, s92, 1
    s_lshl_b32 s92, s92, 1
    v_mov_b32 v51, s92
    ds_read_b32 v48, v51 offset:14144
    s_waitcnt lgkmcnt(0)
    v_readfirstlane_b32 s63, v48
    s_nop 0
    s_sub_u32 s63, s63, 1
    s_cselect_b32 s63, 0x20000000, s63
    s_and_b32 s92, s69, 1
    s_lshl_b32 s92, s92, 12
    s_add_u32 s63, s63, s92
    s_branch L_res_done1
L_slow1:
    s_bcnt1_i32_b32 s74, s73
    s_cmp_ge_u32 s74, 4
    s_cbranch_scc1 L_slow1_4
    s_cmp_ge_u32 s74, 2
    s_cbranch_scc1 L_slow1_2
    s_cmp_eq_u32 s74, 1
    s_cbranch_scc1 L_slow1_1
    s_waitcnt vmcnt(0)
    s_branch L_wok1
L_slow1_1:
    s_waitcnt vmcnt(6)
    s_branch L_wok1
L_slow1_2:
    s_waitcnt vmcnt(18)
    s_cmp_eq_u32 s74, 3
    s_cbranch_scc1 L_wok1
    s_waitcnt vmcnt(12)
    s_branch L_wok1
L_slow1_4:
    s_waitcnt vmcnt(36)
    s_cmp_eq_u32 s74, 6
    s_cbranch_scc1 L_wok1
    s_waitcnt vmcnt(30)
    s_cmp_eq_u32 s74, 5
    s_cbranch_scc1 L_wok1
    s_waitcnt vmcnt(24)
    s_branch L_wok1
L_none2:
    s_and_b32 s73, s72, 0xff
    s_cbranch_scc1 L_noiss2
    s_cmp_ge_u32 s63, 0x40000000
    s_cbranch_scc1 L_exit
    s_add_u32 s70, s70, 1
    s_cmp_lt_u32 s70, 4194304
    s_cbranch_scc1 L_noiss2
    s_branch L_exit
L_sw2:
    ds_read_b32 v46, v210
    s_add_u32 s70, s70, 1
    s_cmp_ge_u32 s70, 4194304
    s_cbranch_scc1 L_sok2
    s_waitcnt lgkmcnt(0)
    v_cmp_eq_u32 vcc, -1, v46
    s_cbranch_vccnz L_sw2
    s_branch L_sok2
L_resx2:
    s_bitcmp1_b32 s63, 29
    s_cbranch_scc0 L_res_done2
L_pool2:
    s_sub_u32 s92, s69, 488
    s_lshl_b32 s83, s3, 6
    s_add_u32 s83, s83, 16384
    s_mov_b32 s82, 0
    s_andn2_b32 s92, s92, 1
    s_lshl_b32 s92, s92, 1
    v_mov_b32 v51, s92
    ds_read_b32 v48, v51 offset:14144
    s_waitcnt lgkmcnt(0)
    v_readfirstlane_b32 s63, v48
    s_nop 0
    s_sub_u32 s63, s63, 1
    s_cselect_b32 s63, 0x20000000, s63
    s_and_b32 s92, s69, 1
    s_lshl_b32 s92, s92, 12
    s_add_u32 s63, s63, s92
    s_branch L_res_done2
L_slow2:
    s_bcnt1_i32_b32 s74, s73
    s_cmp_ge_u32 s74, 4
    s_cbranch_scc1 L_slow2_4
    s_cmp_ge_u32 s74, 2
    s_cbranch_scc1 L_slow2_2
    s_cmp_eq_u32 s74, 1
    s_cbranch_scc1 L_slow2_1
    s_waitcnt vmcnt(0)
    s_branch L_wok2
L_slow2_1:
    s_waitcnt vmcnt(6)
    s_branch L_wok2
L_slow2_2:
    s_waitcnt vmcnt(18)
    s_cmp_eq_u32 s74, 3
    s_cbranch_scc1 L_wok2
    s_waitcnt vmcnt(12)
    s_branch L_wok2
L_slow2_4:
    s_waitcnt vmcnt(36)
    s_cmp_eq_u32 s74, 6
    s_cbranch_scc1 L_wok2
    s_waitcnt vmcnt(30)
    s_cmp_eq_u32 s74, 5
    s_cbranch_scc1 L_wok2
    s_waitcnt vmcnt(24)
    s_branch L_wok2
L_none3:
    s_and_b32 s73, s72, 0xff
    s_cbranch_scc1 L_noiss3
    s_cmp_ge_u32 s63, 0x40000000
    s_cbranch_scc1 L_exit
    s_add_u32 s70, s70, 1
    s_cmp_lt_u32 s70, 4194304
    s_cbranch_scc1 L_noiss3
    s_branch L_exit
L_sw3:
    ds_read_b32 v46, v211
    s_add_u32 s70, s70, 1
    s_cmp_ge_u32 s70, 4194304
    s_cbranch_scc1 L_sok3
    s_waitcnt lgkmcnt(0)
    v_cmp_eq_u32 vcc, -1, v46
    s_cbranch_vccnz L_sw3
    s_branch L_sok3
L_resx3:
    s_bitcmp1_b32 s63, 29
    s_cbranch_scc0 L_res_done3
L_pool3:
    s_sub_u32 s92, s69, 488
    s_lshl_b32 s83, s3, 6
    s_add_u32 s83, s83, 16384
    s_mov_b32 s82, 0
    s_andn2_b32 s92, s92, 1
    s_lshl_b32 s92, s92, 1
    v_mov_b32 v51, s92
    ds_read_b32 v48, v51 offset:14144
    s_waitcnt lgkmcnt(0)
    v_readfirstlane_b32 s63, v48
    s_nop 0
    s_sub_u32 s63, s63, 1
    s_cselect_b32 s63, 0x20000000, s63
    s_and_b32 s92, s69, 1
    s_lshl_b32 s92, s92, 12
    s_add_u32 s63, s63, s92
    s_branch L_res_done3
L_slow3:
    s_bcnt1_i32_b32 s74, s73
    s_cmp_ge_u32 s74, 4
    s_cbranch_scc1 L_slow3_4
    s_cmp_ge_u32 s74, 2
    s_cbranch_scc1 L_slow3_2
    s_cmp_eq_u32 s74, 1
    s_cbranch_scc1 L_slow3_1
    s_waitcnt vmcnt(0)
    s_branch L_wok3
L_slow3_1:
    s_waitcnt vmcnt(6)
    s_branch L_wok3
L_slow3_2:
    s_waitcnt vmcnt(18)
    s_cmp_eq_u32 s74, 3
    s_cbranch_scc1 L_wok3
    s_waitcnt vmcnt(12)
    s_branch L_wok3
L_slow3_4:
    s_waitcnt vmcnt(36)
    s_cmp_eq_u32 s74, 6
    s_cbranch_scc1 L_wok3
    s_waitcnt vmcnt(30)
    s_cmp_eq_u32 s74, 5
    s_cbranch_scc1 L_wok3
    s_waitcnt vmcnt(24)
    s_branch L_wok3
L_none4:
    s_and_b32 s73, s72, 0xff
    s_cbranch_scc1 L_noiss4
    s_cmp_ge_u32 s63, 0x40000000
    s_cbranch_scc1 L_exit
    s_add_u32 s70, s70, 1
    s_cmp_lt_u32 s70, 4194304
    s_cbranch_scc1 L_noiss4
    s_branch L_exit
L_sw4:
    ds_read_b32 v46, v212
    s_add_u32 s70, s70, 1
    s_cmp_ge_u32 s70, 4194304
    s_cbranch_scc1 L_sok4
    s_waitcnt lgkmcnt(0)
    v_cmp_eq_u32 vcc, -1, v46
    s_cbranch_vccnz L_sw4
    s_branch L_sok4
L_resx4:
    s_bitcmp1_b32 s63, 29
    s_cbranch_scc0 L_res_done4
L_pool4:
    s_sub_u32 s92, s69, 488
    s_lshl_b32 s83, s3, 6
    s_add_u32 s83, s83, 16384
    s_mov_b32 s82, 0
    s_andn2_b32 s92, s92, 1
    s_lshl_b32 s92, s92, 1
    v_mov_b32 v51, s92
    ds_read_b32 v48, v51 offset:14144
    s_waitcnt lgkmcnt(0)
    v_readfirstlane_b32 s63, v48
    s_nop 0
    s_sub_u32 s63, s63, 1
    s_cselect_b32 s63, 0x20000000, s63
    s_and_b32 s92, s69, 1
    s_lshl_b32 s92, s92, 12
    s_add_u32 s63, s63, s92
    s_branch L_res_done4
L_slow4:
    s_bcnt1_i32_b32 s74, s73
    s_cmp_ge_u32 s74, 4
    s_cbranch_scc1 L_slow4_4
    s_cmp_ge_u32 s74, 2
    s_cbranch_scc1 L_slow4_2
    s_cmp_eq_u32 s74, 1
    s_cbranch_scc1 L_slow4_1
    s_waitcnt vmcnt(0)
    s_branch L_wok4
L_slow4_1:
    s_waitcnt vmcnt(6)
    s_branch L_wok4
L_slow4_2:
    s_waitcnt vmcnt(18)
    s_cmp_eq_u32 s74, 3
    s_cbranch_scc1 L_wok4
    s_waitcnt vmcnt(12)
    s_branch L_wok4
L_slow4_4:
    s_waitcnt vmcnt(36)
    s_cmp_eq_u32 s74, 6
    s_cbranch_scc1 L_wok4
    s_waitcnt vmcnt(30)
    s_cmp_eq_u32 s74, 5
    s_cbranch_scc1 L_wok4
    s_waitcnt vmcnt(24)
    s_branch L_wok4
L_none5:
    s_and_b32 s73, s72, 0xff
    s_cbranch_scc1 L_noiss5
    s_cmp_ge_u32 s63, 0x40000000
    s_cbranch_scc1 L_exit
    s_add_u32 s70, s70, 1
    s_cmp_lt_u32 s70, 4194304
    s_cbranch_scc1 L_noiss5
    s_branch L_exit
L_sw5:
    ds_read_b32 v46, v213
    s_add_u32 s70, s70, 1
    s_cmp_ge_u32 s70, 4194304
    s_cbranch_scc1 L_sok5
    s_waitcnt lgkmcnt(0)
    v_cmp_eq_u32 vcc, -1, v46
    s_cbranch_vccnz L_sw5
    s_branch L_sok5
L_resx5:
    s_bitcmp1_b32 s63, 29
    s_cbranch_scc0 L_res_done5
L_pool5:
    s_sub_u32 s92, s69, 488
    s_lshl_b32 s83, s3, 6
    s_add_u32 s83, s83, 16384
    s_mov_b32 s82, 0
    s_andn2_b32 s92, s92, 1
    s_lshl_b32 s92, s92, 1
    v_mov_b32 v51, s92
    ds_read_b32 v48, v51 offset:14144
    s_waitcnt lgkmcnt(0)
    v_readfirstlane_b32 s63, v48
    s_nop 0
    s_sub_u32 s63, s63, 1
    s_cselect_b32 s63, 0x20000000, s63
    s_and_b32 s92, s69, 1
    s_lshl_b32 s92, s92, 12
    s_add_u32 s63, s63, s92
    s_branch L_res_done5
L_slow5:
    s_bcnt1_i32_b32 s74, s73
    s_cmp_ge_u32 s74, 4
    s_cbranch_scc1 L_slow5_4
    s_cmp_ge_u32 s74, 2
    s_cbranch_scc1 L_slow5_2
    s_cmp_eq_u32 s74, 1
    s_cbranch_scc1 L_slow5_1
    s_waitcnt vmcnt(0)
    s_branch L_wok5
L_slow5_1:
    s_waitcnt vmcnt(6)
    s_branch L_wok5
L_slow5_2:
    s_waitcnt vmcnt(18)
    s_cmp_eq_u32 s74, 3
    s_cbranch_scc1 L_wok5
    s_waitcnt vmcnt(12)
    s_branch L_wok5
L_slow5_4:
    s_waitcnt vmcnt(36)
    s_cmp_eq_u32 s74, 6
    s_cbranch_scc1 L_wok5
    s_waitcnt vmcnt(30)
    s_cmp_eq_u32 s74, 5
    s_cbranch_scc1 L_wok5
    s_waitcnt vmcnt(24)
    s_branch L_wok5
L_none6:
    s_and_b32 s73, s72, 0xff
    s_cbranch_scc1 L_noiss6
    s_cmp_ge_u32 s63, 0x40000000
    s_cbranch_scc1 L_exit
    s_add_u32 s70, s70, 1
    s_cmp_lt_u32 s70, 4194304
    s_cbranch_scc1 L_noiss6
    s_branch L_exit
L_sw6:
    ds_read_b32 v46, v214
    s_add_u32 s70, s70, 1
    s_cmp_ge_u32 s70, 4194304
    s_cbranch_scc1 L_sok6
    s_waitcnt lgkmcnt(0)
    v_cmp_eq_u32 vcc, -1, v46
    s_cbranch_vccnz L_sw6
    s_branch L_sok6
L_resx6:
    s_bitcmp1_b32 s63, 29
    s_cbranch_scc0 L_res_done6
L_pool6:
    s_sub_u32 s92, s69, 488
    s_lshl_b32 s83, s3, 6
    s_add_u32 s83, s83, 16384
    s_mov_b32 s82, 0
    s_andn2_b32 s92, s92, 1
    s_lshl_b32 s92, s92, 1
    v_mov_b32 v51, s92
    ds_read_b32 v48, v51 offset:14144
    s_waitcnt lgkmcnt(0)
    v_readfirstlane_b32 s63, v48
    s_nop 0
    s_sub_u32 s63, s63, 1
    s_cselect_b32 s63, 0x20000000, s63
    s_and_b32 s92, s69, 1
    s_lshl_b32 s92, s92, 12
    s_add_u32 s63, s63, s92
    s_branch L_res_done6
L_slow6:
    s_bcnt1_i32_b32 s74, s73
    s_cmp_ge_u32 s74, 4
    s_cbranch_scc1 L_slow6_4
    s_cmp_ge_u32 s74, 2
    s_cbranch_scc1 L_slow6_2
    s_cmp_eq_u32 s74, 1
    s_cbranch_scc1 L_slow6_1
    s_waitcnt vmcnt(0)
    s_branch L_wok6
L_slow6_1:
    s_waitcnt vmcnt(6)
    s_branch L_wok6
L_slow6_2:
    s_waitcnt vmcnt(18)
    s_cmp_eq_u32 s74, 3
    s_cbranch_scc1 L_wok6
    s_waitcnt vmcnt(12)
    s_branch L_wok6
L_slow6_4:
    s_waitcnt vmcnt(36)
    s_cmp_eq_u32 s74, 6
    s_cbranch_scc1 L_wok6
    s_waitcnt vmcnt(30)
    s_cmp_eq_u32 s74, 5
    s_cbranch_scc1 L_wok6
    s_waitcnt vmcnt(24)
    s_branch L_wok6
L_none7:
    s_and_b32 s73, s72, 0xff
    s_cbranch_scc1 L_noiss7
    s_cmp_ge_u32 s63, 0x40000000
    s_cbranch_scc1 L_exit
    s_add_u32 s70, s70, 1
    s_cmp_lt_u32 s70, 4194304
    s_cbranch_scc1 L_noiss7
    s_branch L_exit
L_sw7:
    ds_read_b32 v46, v215
    s_add_u32 s70, s70, 1
    s_cmp_ge_u32 s70, 4194304
    s_cbranch_scc1 L_sok7
    s_waitcnt lgkmcnt(0)
    v_cmp_eq_u32 vcc, -1, v46
    s_cbranch_vccnz L_sw7
    s_branch L_sok7
L_resx7:
    s_bitcmp1_b32 s63, 29
    s_cbranch_scc0 L_res_done7
L_pool7:
    s_sub_u32 s92, s69, 488
    s_lshl_b32 s83, s3, 6
    s_add_u32 s83, s83, 16384
    s_mov_b32 s82, 0
    s_andn2_b32 s92, s92, 1
    s_lshl_b32 s92, s92, 1
    v_mov_b32 v51, s92
    ds_read_b32 v48, v51 offset:14144
    s_waitcnt lgkmcnt(0)
    v_readfirstlane_b32 s63, v48
    s_nop 0
    s_sub_u32 s63, s63, 1
    s_cselect_b32 s63, 0x20000000, s63
    s_and_b32 s92, s69, 1
    s_lshl_b32 s92, s92, 12
    s_add_u32 s63, s63, s92
    s_branch L_res_done7
L_slow7:
    s_bcnt1_i32_b32 s74, s73
    s_cmp_ge_u32 s74, 4
    s_cbranch_scc1 L_slow7_4
    s_cmp_ge_u32 s74, 2
    s_cbranch_scc1 L_slow7_2
    s_cmp_eq_u32 s74, 1
    s_cbranch_scc1 L_slow7_1
    s_waitcnt vmcnt(0)
    s_branch L_wok7
L_slow7_1:
    s_waitcnt vmcnt(6)
    s_branch L_wok7
L_slow7_2:
    s_waitcnt vmcnt(18)
    s_cmp_eq_u32 s74, 3
    s_cbranch_scc1 L_wok7
    s_waitcnt vmcnt(12)
    s_branch L_wok7
L_slow7_4:
    s_waitcnt vmcnt(36)
    s_cmp_eq_u32 s74, 6
    s_cbranch_scc1 L_wok7
    s_waitcnt vmcnt(30)
    s_cmp_eq_u32 s74, 5
    s_cbranch_scc1 L_wok7
    s_waitcnt vmcnt(24)
    s_branch L_wok7
L_rescale:
    v_max_f32 v36, v12, v13
    s_nop 1
    v_max_f32_dpp v36, v36, v36 row_ror:8 row_mask:0xf bank_mask:0xf
    v_mov_b32 v37, v36
    s_nop 1
    v_permlane32_swap_b32 v36, v37
    s_nop 1
    v_max_f32 v36, v36, v37
    v_mov_b32 v37, v36
    s_nop 1
    v_permlane16_swap_b32 v36, v37
    s_nop 1
    v_max_f32 v36, v36, v37
    v_mul_f32 v36, s65, v36
    v_max_f32 v36, v36, -v8
    v_sub_f32 v37, 0, v36
    v_sub_f32 v38, v37, v8
    v_exp_f32 v38, v38
    v_mov_b32 v8, v37
    s_nop 0
    v_mul_f32 v10, v10, v38
    v_mov_b32_dpp v14, v38 row_newbcast:0 row_mask:0xf bank_mask:0xf
    v_mov_b32_dpp v15, v38 row_newbcast:4 row_mask:0xf bank_mask:0xf
    v_mul_f32 v224, v224, v14
    v_mul_f32 v225, v225, v14
    v_mul_f32 v226, v226, v14
    v_mul_f32 v227, v227, v14
    v_mul_f32 v228, v228, v14
    v_mul_f32 v229, v229, v14
    v_mul_f32 v230, v230, v14
    v_mul_f32 v231, v231, v14
    v_mul_f32 v232, v232, v15
    v_mul_f32 v233, v233, v15
    v_mul_f32 v234, v234, v15
    v_mul_f32 v235, v235, v15
    v_mul_f32 v236, v236, v15
    v_mul_f32 v237, v237, v15
    v_mul_f32 v238, v238, v15
    v_mul_f32 v239, v239, v15
    s_cmp_eq_u32 s75, 0
    s_cbranch_scc1 L_retry0
    s_cmp_eq_u32 s75, 1
    s_cbranch_scc1 L_retry1
    s_cmp_eq_u32 s75, 2
    s_cbranch_scc1 L_retry2
    s_cmp_eq_u32 s75, 3
    s_cbranch_scc1 L_retry3
    s_cmp_eq_u32 s75, 4
    s_cbranch_scc1 L_retry4
    s_cmp_eq_u32 s75, 5
    s_cbranch_scc1 L_retry5
    s_cmp_eq_u32 s75, 6
    s_cbranch_scc1 L_retry6
    s_branch L_retry7
L_agent:
    s_mov_b32 s70, 0
L_ag_en:
    s_sleep 16
    ds_read_b32 v48, v49 offset:5644
    s_waitcnt lgkmcnt(0)
    v_readfirstlane_b32 s69, v48
    s_add_u32 s70, s70, 1
    s_cmp_lg_u32 s69, 0
    s_cbranch_scc1 L_ag_en_ok
    s_cmp_lt_u32 s70, 1048576
    s_cbranch_scc1 L_ag_en
L_ag_en_ok:
    s_mov_b32 s60, s69
    ds_read_b32 v45, v49 offset:5664
    v_lshlrev_b32 v249, 2, v2
    ds_read_b32 v250, v249 offset:256
    ds_read_b32 v251, v249 offset:512
    ds_read_b32 v249, v249 offset:0
    s_waitcnt lgkmcnt(0)
    v_readfirstlane_b32 s88, v45
    s_nop 0
    s_lshr_b32 s100, s88, 24
    s_sub_u32 s101, s100, 144
    s_sub_u32 s95, s100, 162
    s_mov_b32 s96, 0
    s_mov_b32 s70, 0
    s_mov_b32 s98, 0
    s_mov_b32 s99, 0
    s_mov_b32 s97, 488
    v_mov_b32 v52, 0
    s_mov_b32 s72, 0
    v_lshrrev_b32 v19, 2, v2
    s_movk_i32 s62, 9216
    v_mul_lo_u32 v19, v19, s62
    v_and_b32 v32, 3, v2
    v_lshlrev_b32 v32, 4, v32
    s_lshl_b32 s62, s100, 6
    s_cmp_lt_u32 s100, 144
    s_cselect_b32 s62, s62, 0
    v_add3_u32 v19, v19, v32, s62
    s_mov_b32 s62, 35
    s_mov_b32 s75, 0
    s_mov_b32 s74, 0
    s_mov_b64 exec, 0
    s_branch L_ag_dma
L_ag_loop:
    ds_read_b32 v48, v49 offset:5636
    s_cmp_eq_u32 s98, s99
    s_cbranch_scc1 L_ag_nocompl
    v_readlane_b32 s63, v52, s99
    s_nop 0
    s_bitcmp1_b32 s63, 0
    s_cbranch_scc0 L_ag_nocompl
    s_add_u32 s99, s99, 1
    s_lshr_b32 s69, s63, 1
L_ag_put:
    s_cmp_ge_u32 s69, 96
    s_cbranch_scc1 L_ag_fail
    s_lshl_b32 s69, s69, 1
    s_bfe_u32 s63, s69, 0x40002
    s_andn2_b32 s68, s2, 15
    s_add_u32 s68, s68, s63
    s_mul_i32 s68, s68, 0
    s_lshl_b32 s63, s63, 20
    s_lshr_b32 s92, s69, 6
    s_add_u32 s92, s92, 61
    s_add_u32 s92, s92, s68
    s_and_b32 s92, s92, 63
    s_lshl_b32 s92, s92, 14
    s_add_u32 s63, s63, s92
    s_and_b32 s92, s69, 3
    s_lshl_b32 s92, s92, 12
    s_add_u32 s63, s63, s92
    s_add_u32 s63, s63, 1
    s_lshl_b32 s92, s96, 2
    v_mov_b32 v51, s92
    v_mov_b32 v53, s63
    ds_write_b32 v51, v53 offset:14144
    s_add_u32 s96, s96, 1
L_ag_nocompl:
    s_waitcnt lgkmcnt(0)
    v_readfirstlane_b32 s69, v48
    s_sub_u32 s92, s98, s99
    s_cmp_ge_u32 s92, 6
    s_cbranch_scc1 L_ag_idle
    s_add_u32 s92, s69, 488
    s_lshr_b32 s92, s92, 1
    s_cmp_lt_u32 s69, 488
    s_cselect_b32 s69, s92, s69
    s_sub_u32 s92, s97, s69
    s_cmp_lt_i32 s92, 2
    s_cbranch_scc0 L_ag_idle
    v_writelane_b32 v52, 2, s98
    s_lshl_b64 exec, 1, s98
    s_add_u32 s97, s97, 2
    s_add_u32 s98, s98, 1
    buffer_atomic_add v52, v49, s[20:23], s71 offen sc0 sc1
    s_mov_b64 exec, -1
    s_branch L_ag_loop
L_ag_idle:
    s_cmp_eq_u32 s97, 0x7fffffff
    s_cbranch_scc1 L_ag_fail
    s_sleep 2
    s_add_u32 s70, s70, 1
    s_cmp_lt_u32 s70, 2097152
    s_cbranch_scc1 L_ag_loop
L_ag_fail:
    s_waitcnt vmcnt(0) lgkmcnt(0)
    s_mov_b32 s97, 0x7fffffff
    s_add_u32 s70, s70, 1
    s_cmp_ge_u32 s70, 2097408
    s_cbranch_scc1 L_ag_exh
    s_cmp_lg_u32 s98, s99
    s_cbranch_scc1 L_ag_loop
L_ag_exh:
    s_lshl_b32 s92, s96, 2
    v_mov_b32 v51, s92
    v_mov_b32 v48, 0x40000001
    ds_write_b32 v51, v48 offset:14144
    ds_write_b32 v51, v48 offset:14148
    ds_write_b32 v51, v48 offset:14152
    ds_write_b32 v51, v48 offset:14156
    s_waitcnt lgkmcnt(0)
    s_cmp_ge_u32 s100, 144
    s_cbranch_scc1 L_bar1
    s_mul_i32 s92, s96, 2
    s_add_u32 s92, s92, 492
    s_mov_b32 s70, 0
    s_mov_b32 s62, 0
    s_mov_b32 s75, 1
    s_mul_i32 s74, s100, 36864
L_ag_trig:
    ds_read_b32 v48, v49 offset:5636
    s_waitcnt lgkmcnt(0)
    v_readfirstlane_b32 s69, v48
    s_add_u32 s70, s70, 1
    s_cmp_ge_u32 s69, s92
    s_cbranch_scc1 L_ag_go
    s_sleep 1
    s_cmp_lt_u32 s70, 1048576
    s_cbranch_scc1 L_ag_trig
L_ag_go:
L_ag_dma:
    s_lshl_b32 s69, s62, 10
    s_mul_i32 s63, s62, 147456
    s_add_u32 m0, s69, 24640
    s_waitcnt vmcnt(40)
    buffer_load_dwordx4 v19, s[36:39], s63 offen lds
    s_add_u32 s63, s74, s69
    s_add_u32 m0, s69, 61504
    s_add_u32 s62, s62, 1
    buffer_load_dwordx4 v6, s[40:43], s63 offen nt lds
    s_cmp_lt_u32 s62, 36
    s_cbranch_scc1 L_ag_dma
    s_mov_b64 exec, -1
    s_cmp_eq_u32 s75, 0
    s_cbranch_scc1 L_ag_loop
    s_waitcnt vmcnt(0)
    s_branch L_bar1
L_exit:
    s_cmp_lt_u32 s3, 4
    s_cbranch_scc1 L_tail
    s_cmp_lg_u32 s3, 5
    s_cbranch_scc1 L_early
    s_setprio 0
    s_mov_b32 s70, 0
L_drw:
    s_sleep 32
    ds_read_b32 v48, v49 offset:5644
    ds_read_b32 v45, v49 offset:5664
    s_waitcnt lgkmcnt(0)
    v_readfirstlane_b32 s69, v48
    s_add_u32 s70, s70, 1
    s_cmp_lg_u32 s69, 0
    s_cbranch_scc1 L_drok
    s_cmp_lt_u32 s70, 1048576
    s_cbranch_scc1 L_drw
L_drok:
    s_mov_b32 s93, 1
    s_mov_b32 s3, 0
    s_setprio 0
    v_mov_b32 v14, 0
    v_mov_b32 v15, 0
    v_mov_b32 v16, 0
    v_mov_b32 v17, 0
    v_mov_b32 v18, 0
    v_mov_b32 v19, 0
    v_mov_b32 v36, 0
    v_mov_b32 v41, 0
    s_mov_b64 exec, 0
    s_mov_b64 s[86:87], 0
    s_branch L_tail
L_early:
    s_mov_b32 s70, 0
    v_mov_b32 v49, 0
    v_mov_b32 v50, 1
    s_waitcnt vmcnt(0)
    s_nop 1
    v_mov_b32_dpp v9, v8 row_newbcast:4 row_mask:0xf bank_mask:0xf
    v_mov_b32_dpp v11, v10 row_newbcast:4 row_mask:0xf bank_mask:0xf
    v_mov_b32_dpp v14, v10 row_newbcast:0 row_mask:0xf bank_mask:0xf
    v_mov_b32_dpp v8, v8 row_newbcast:0 row_mask:0xf bank_mask:0xf
    v_add_f32_dpp v11, v10, v11 row_newbcast:12 row_mask:0xf bank_mask:0xf
    v_add_f32_dpp v10, v10, v14 row_newbcast:8 row_mask:0xf bank_mask:0xf
    v_lshrrev_b32 v14, 5, v2
    v_lshlrev_b32 v15, 9, v14
    v_and_b32 v20, 15, v2
    v_permlane32_swap_b32 v10, v11
    v_permlane32_swap_b32 v224, v232
    v_permlane32_swap_b32 v225, v233
    v_permlane32_swap_b32 v226, v234
    v_permlane32_swap_b32 v227, v235
    v_permlane32_swap_b32 v228, v236
    v_permlane32_swap_b32 v229, v237
    v_permlane32_swap_b32 v230, v238
    v_permlane32_swap_b32 v231, v239
    v_add_f32 v10, v10, v11
    v_add_f32 v224, v224, v232
    v_add_f32 v225, v225, v233
    v_add_f32 v226, v226, v234
    v_add_f32 v227, v227, v235
    v_add_f32 v228, v228, v236
    v_add_f32 v229, v229, v237
    v_add_f32 v230, v230, v238
    v_add_f32 v231, v231, v239
    v_mov_b32 v11, v10
    v_cmp_le_u32 vcc, 32, v2
    v_lshl_add_u32 v15, v20, 5, v15
    v_bfe_u32 v20, v2, 4, 1
    v_permlane16_swap_b32 v224, v228
    v_permlane16_swap_b32 v225, v229
    v_permlane16_swap_b32 v226, v230
    v_permlane16_swap_b32 v227, v231
    v_permlane16_swap_b32 v10, v11
    v_lshl_add_u32 v15, v20, 4, v15
    s_lshl_b32 s62, s3, 10
    v_add_u32 v15, s62, v15
    v_add_f32 v224, v224, v228
    v_add_f32 v225, v225, v229
    v_add_f32 v226, v226, v230
    v_add_f32 v227, v227, v231
    v_cndmask_b32 v20, v8, v9, vcc
    ds_write_b128 v15, v[224:227] offset:5696
    s_lshl_b32 s62, s3, 4
    v_sub_f32 v20, 0, v20
    v_lshlrev_b32 v14, 3, v14
    v_add_f32 v21, v10, v11
    v_add_u32 v15, s62, v14
    ds_write_b64 v15, v[20:21] offset:13888
    s_mov_b64 exec, 1
    ds_add_u32 v49, v50 offset:5648
    s_mov_b64 exec, -1
L_dcwait:
    ds_read_b32 v48, v49 offset:5640
    s_waitcnt lgkmcnt(0)
    v_readfirstlane_b32 s69, v48
    s_add_u32 s70, s70, 1
    s_cmp_ge_u32 s69, 8
    s_cbranch_scc1 L_dc_ok
    s_sleep 4
    s_cmp_lt_u32 s70, 1048576
    s_cbranch_scc1 L_dcwait
L_dc_ok:
    s_waitcnt lgkmcnt(0)
    s_cmp_eq_u32 s3, 4
    s_cbranch_scc1 L_agent
    s_mov_b32 s70, 0
    s_cmp_lg_u32 s3, 7
    s_cbranch_scc1 L_nwait
    s_lshr_b64 s[84:85], s[84:85], 4
    s_xor_b32 s85, s85, 0x5a3c96e1
    s_mov_b32 s72, 1900544
    ds_read_b64 v[24:25], v49 offset:5672
    s_load_dwordx2 s[76:77], s[0:1], 56
    s_load_dwordx2 s[24:25], s[0:1], 0
    v_and_b32 v26, 1, v2
    v_cmp_eq_u32 vcc, 1, v26
    v_lshlrev_b32 v26, 1, v2
    v_and_b32 v26, 28, v26
    s_and_b32 s62, s2, 15
    s_lshr_b32 s68, s2, 4
    s_waitcnt lgkmcnt(0)
    v_cndmask_b32 v24, v24, v25, vcc
    v_bfe_u32 v24, v24, v26, 3
    v_lshl_add_u32 v24, v24, 4, v2
    s_nop 0
    v_readlane_b32 s69, v24, s62
    s_mov_b64 exec, 0xffff
    s_nop 2
    v_cmp_gt_u32 vcc, s69, v24
    s_bcnt1_i32_b64 s63, vcc
    v_cmp_gt_u32 vcc, 64, v24
    s_bcnt1_i32_b64 s75, vcc
    s_mov_b64 exec, -1
    s_lshr_b32 s90, s69, 6
    s_lshr_b32 s69, s63, 1
    s_and_b32 s63, s63, 1
    s_add_u32 s69, s69, s68
    s_and_b32 s69, s69, 7
    s_lshl_b32 s70, s69, 4
    s_add_u32 s70, s70, s68
    s_lshl_b32 s70, s70, 1
    s_add_u32 s70, s70, s63
    s_cmp_lt_u32 s70, 162
    s_cselect_b32 s100, s70, 0xff
    s_lshl_b32 s70, s69, 1
    s_add_u32 s70, s70, s63
    s_add_u32 s70, s70, 150
    s_cmp_ge_u32 s69, 6
    s_cselect_b32 s100, s70, s100
    s_sub_u32 s101, s100, 144
    s_sub_u32 s95, s100, 162
    s_cmp_lt_u32 s100, 144
    s_cselect_b32 s73, s100, 0
    s_cmp_lt_u32 s101, 18
    s_cselect_b32 s74, s101, 0
    s_cselect_b32 s70, s72, 0x40000000
    s_lshl_b32 s62, s74, 7
    s_add_u32 s70, s70, s62
    s_xor_b32 s62, s84, s85
    v_mov_b32 v24, s90
    v_mov_b32 v25, s84
    v_mov_b32 v26, s90
    v_mov_b32 v27, s62
    s_mov_b64 exec, 1
    buffer_store_dwordx4 v[24:27], v49, s[20:23], s70 offen offset:1024 sc1
    s_mov_b64 exec, -1
    s_lshl_b32 s73, s73, 6
    s_lshl_b32 s74, s74, 6
    v_and_b32 v28, 7, v2
    v_lshrrev_b32 v29, 4, v2
    v_lshl_add_u32 v28, v29, 3, v28
    v_lshlrev_b32 v28, 1, v28
    v_lshlrev_b32 v29, 1, v248
    s_and_b32 s77, s77, 0xffff
    s_mov_b32 s78, 9216
    s_mov_b32 s79, 0x00020000
    s_and_b32 s25, s25, 0xffff
    s_mov_b32 s26, 1152
    s_mov_b32 s27, 0x00020000
    buffer_load_ushort v249, v28, s[76:79], s73 offen
    buffer_load_ushort v250, v29, s[24:27], s74 offen
    buffer_load_ushort v251, v29, s[48:51], s74 offen
    s_sub_u32 s62, 6, s68
    s_and_b32 s62, s62, 7
    s_lshl_b32 s62, s62, 1
    s_cmp_ge_u32 s62, s75
    s_cselect_b32 s88, 262144, 0
    s_add_u32 s62, s62, 2
    s_and_b32 s62, s62, 14
    s_cmp_ge_u32 s62, s75
    s_cselect_b32 s62, 524288, 0
    s_or_b32 s88, s88, s62
    s_lshl_b32 s62, s100, 24
    s_or_b32 s88, s88, s62
    s_xor_b32 s88, s88, 786432
    v_lshlrev_b32 v28, 2, v2
    s_waitcnt vmcnt(0)
    ds_write_b32 v28, v249 offset:0
    ds_write_b32 v28, v250 offset:256
    ds_write_b32 v28, v251 offset:512
    s_mov_b32 s70, 0
L_lidok:
    s_sub_u32 s84, s84, 250
L_nget:
    s_mov_b64 exec, 1
    buffer_load_dwordx4 v[24:27], v49, s[20:23], s72 offen offset:0 sc1
    s_mov_b64 exec, -1
    s_waitcnt vmcnt(0)
    v_readfirstlane_b32 s62, v25
    v_readfirstlane_b32 s63, v27
    s_add_u32 s70, s70, 1
    s_xor_b32 s63, s63, s62
    s_xor_b32 s63, s63, s85
    s_sub_u32 s69, s62, s84
    s_lshr_b32 s69, s69, 16
    s_or_b32 s63, s63, s69
    s_cbranch_scc0 L_ngot
    s_sleep 127
    s_cmp_lt_u32 s70, 20000
    s_cbranch_scc1 L_nget
L_ngot:
    s_mul_i32 s60, s62, 0x9E3779B1
    s_bitset1_b32 s60, 0
    s_bitset0_b32 s60, 8
    v_readfirstlane_b32 s63, v24
    s_nop 0
    s_bfe_u32 s69, s63, 0x120001
    s_or_b32 s88, s88, s69
    s_bitcmp1_b32 s63, 0
    s_cselect_b32 s69, 0xfffff, 0
    s_xor_b32 s88, s88, s69
    v_mov_b32 v48, s88
    ds_write_b32 v49, v48 offset:5664
    v_readfirstlane_b32 s63, v24
    s_bitset0_b32 s60, 13
    s_and_b32 s63, s63, 1
    s_lshl_b32 s63, s63, 13
    s_or_b32 s60, s60, s63
    v_mov_b32 v48, s60
    v_mov_b32 v47, s62
    ds_write_b32 v49, v47 offset:5652
    ds_write_b32 v49, v48 offset:5644
    s_branch L_bar1
L_nwait:
    s_cmp_lg_u32 s3, 6
    s_cbranch_scc1 L_nopb
    s_lshr_b64 s[84:85], s[84:85], 4
    s_xor_b32 s85, s85, 0x5a3c96e1
    s_mov_b32 s72, 1900544
    s_cmp_lg_u32 s2, 0
    s_cbranch_scc1 L_nopb
    s_mov_b32 s74, 0
L_pb:
    s_and_b32 s62, s70, 1
    s_lshl_b32 s62, s62, 12
    s_and_b32 s63, s70, 2
    s_lshl_b32 s63, s63, 13
    s_add_u32 s62, s62, s63
    s_lshr_b32 s63, s70, 2
    s_lshl_b32 s63, s63, 7
    s_add_u32 s62, s62, s63
    s_add_u32 s62, s62, 1867776
    s_add_u32 s63, s62, 8192
    s_memtime s[90:91]
    s_waitcnt lgkmcnt(0)
    s_buffer_load_dword s73, s[20:23], s62
    s_waitcnt lgkmcnt(0)
    s_memtime s[68:69]
    s_waitcnt lgkmcnt(0)
    s_buffer_load_dword s73, s[20:23], s63
    s_waitcnt lgkmcnt(0)
    s_memtime s[76:77]
    s_waitcnt lgkmcnt(0)
    s_sub_u32 s90, s68, s90
    s_sub_u32 s76, s76, s68
    s_sub_u32 s90, s90, s76
    s_min_i32 s90, s90, 600
    s_max_i32 s90, s90, -600
    s_add_u32 s74, s74, s90
    s_add_u32 s70, s70, 1
    s_cmp_lt_u32 s70, 32
    s_cbranch_scc1 L_pb
    s_cmp_gt_i32 s74, 0
    s_cselect_b32 s74, 1, 0
    s_getreg_b32 s62, hwreg(HW_REG_XCC_ID, 2, 1)
    s_xor_b32 s74, s74, s62
    v_lshlrev_b32 v28, 7, v2
    s_sub_u32 s73, s84, 250
    s_mov_b32 s70, 0
    s_mov_b32 exec_lo, 0x3ffff
    s_mov_b32 exec_hi, 0x0
L_cget:
    buffer_load_dwordx4 v[24:27], v28, s[20:23], s72 offen offset:1024 sc1
    s_waitcnt vmcnt(0)
    v_xor_b32 v27, v27, v25
    v_xor_b32 v27, s85, v27
    v_subrev_u32 v25, s73, v25
    v_lshrrev_b32 v25, 16, v25
    v_or_b32 v25, v25, v27
    v_cmp_ne_u32 vcc, 0, v25
    s_add_u32 s70, s70, 1
    s_cbranch_vccz L_cgot
    s_sleep 32
    s_cmp_lt_u32 s70, 20000
    s_cbranch_scc1 L_cget
L_cgot:
    v_cmp_ne_u32 vcc, 0, v24
    s_mov_b64 exec, -1
    s_lshl_b32 s62, vcc_lo, 1
    s_or_b32 s74, s74, s62
    s_xor_b32 s62, s84, s85
    v_mov_b32 v24, s74
    v_mov_b32 v25, s84
    v_mov_b32 v26, s74
    v_mov_b32 v27, s62
    s_mov_b64 exec, 1
    buffer_store_dwordx4 v[24:27], v49, s[20:23], s72 offen sc1
    s_mov_b64 exec, -1
    s_mov_b32 s70, 0
L_nopb:
L_nwait2:
    s_sleep 32
    ds_read_b32 v48, v49 offset:5644
    s_waitcnt lgkmcnt(0)
    v_readfirstlane_b32 s60, v48
    s_add_u32 s70, s70, 1
    s_cmp_lg_u32 s60, 0
    s_cbranch_scc1 L_lwo
    s_cmp_lt_u32 s70, 1048576
    s_cbranch_scc1 L_nwait2
L_lwo:
    ds_read_b32 v45, v49 offset:5664
    v_lshlrev_b32 v249, 2, v2
    ds_read_b32 v250, v249 offset:256
    ds_read_b32 v251, v249 offset:512
    ds_read_b32 v249, v249 offset:0
    s_waitcnt lgkmcnt(0)
    v_readfirstlane_b32 s88, v45
    s_nop 0
    s_lshr_b32 s100, s88, 24
    s_sub_u32 s101, s100, 144
    s_sub_u32 s95, s100, 162
    s_cmp_lg_u32 s3, 6
    s_cbranch_scc1 L_bar1
    s_cmp_ge_u32 s95, 4
    s_cbranch_scc1 L_bar1
    s_lshr_b32 s68, s2, 4
    s_lshl_b32 s68, s68, 2
    s_add_u32 s68, s68, s95
    s_mul_i32 s68, s68, 73728
    s_mov_b32 s70, 0
    s_mov_b32 s62, 0
L_lwo_w:
    s_sleep 8
    ds_read_b32 v48, v49 offset:5636
    s_waitcnt lgkmcnt(0)
    v_readfirstlane_b32 s69, v48
    s_add_u32 s70, s70, 1
    s_cmp_ge_u32 s69, 472
    s_cbranch_scc1 L_lwo_go
    s_cmp_lt_u32 s70, 65536
    s_cbranch_scc1 L_lwo_w
L_lwo_go:
    s_setprio 0
L_lwo_l:
    s_add_u32 s63, s68, s62
    s_add_u32 m0, s62, 24640
    s_add_u32 s62, s62, 1024
    buffer_load_dwordx4 v6, s[32:35], s63 offen nt lds
    s_cmp_lt_u32 s62, 73728
    s_cbranch_scc1 L_lwo_l
    s_waitcnt vmcnt(0)
    s_branch L_bar1
    v_and_b32 v37, 15, v2
    v_lshlrev_b32 v37, 2, v37
    s_mov_b32 s70, 0
L_poll_all:
    s_sleep 127
    s_sleep 127
    s_sleep 127
    buffer_load_dword v38, v37, s[56:59], 0 offen offset:0 sc1
    s_waitcnt vmcnt(0)
    v_cmp_gt_u32 vcc, 16, v38
    s_add_u32 s70, s70, 1
    s_cbranch_vccz L_pa_done
    s_sleep 8
    s_cmp_lt_u32 s70, 2000
    s_cbranch_scc1 L_poll_all
L_pa_done:
    ds_write_b32 v49, v50 offset:5644
    s_branch L_bar1
L_tail:
    ds_read_b32 v47, v49 offset:5644
    ds_read_b32 v45, v49 offset:5664
    v_lshlrev_b32 v249, 2, v2
    ds_read_b32 v249, v249 offset:0
    s_nop 1
    v_mov_b32_dpp v9, v8 row_newbcast:4 row_mask:0xf bank_mask:0xf
    v_mov_b32_dpp v11, v10 row_newbcast:4 row_mask:0xf bank_mask:0xf
    v_mov_b32_dpp v14, v10 row_newbcast:0 row_mask:0xf bank_mask:0xf
    v_mov_b32_dpp v8, v8 row_newbcast:0 row_mask:0xf bank_mask:0xf
    v_add_f32_dpp v11, v10, v11 row_newbcast:12 row_mask:0xf bank_mask:0xf
    v_add_f32_dpp v10, v10, v14 row_newbcast:8 row_mask:0xf bank_mask:0xf
    v_lshrrev_b32 v14, 5, v2
    v_lshlrev_b32 v15, 9, v14
    v_and_b32 v20, 15, v2
    v_permlane32_swap_b32 v10, v11
    v_permlane32_swap_b32 v224, v232
    v_permlane32_swap_b32 v225, v233
    v_permlane32_swap_b32 v226, v234
    v_permlane32_swap_b32 v227, v235
    v_permlane32_swap_b32 v228, v236
    v_permlane32_swap_b32 v229, v237
    v_permlane32_swap_b32 v230, v238
    v_permlane32_swap_b32 v231, v239
    v_add_f32 v10, v10, v11
    v_add_f32 v224, v224, v232
    v_add_f32 v225, v225, v233
    v_add_f32 v226, v226, v234
    v_add_f32 v227, v227, v235
    v_add_f32 v228, v228, v236
    v_add_f32 v229, v229, v237
    v_add_f32 v230, v230, v238
    v_add_f32 v231, v231, v239
    v_mov_b32 v11, v10
    v_cmp_le_u32 vcc, 32, v2
    v_lshl_add_u32 v15, v20, 5, v15
    v_bfe_u32 v20, v2, 4, 1
    v_permlane16_swap_b32 v224, v228
    v_permlane16_swap_b32 v225, v229
    v_permlane16_swap_b32 v226, v230
    v_permlane16_swap_b32 v227, v231
    v_permlane16_swap_b32 v10, v11
    v_lshl_add_u32 v15, v20, 4, v15
    s_lshl_b32 s62, s3, 10
    v_add_u32 v15, s62, v15
    v_add_f32 v224, v224, v228
    v_add_f32 v225, v225, v229
    v_add_f32 v226, v226, v230
    v_add_f32 v227, v227, v231
    v_cndmask_b32 v20, v8, v9, vcc
    ds_write_b128 v15, v[224:227] offset:5696
    s_lshl_b32 s62, s3, 4
    v_sub_f32 v20, 0, v20
    v_lshlrev_b32 v14, 3, v14
    v_add_f32 v21, v10, v11
    v_add_u32 v15, s62, v14
    ds_write_b64 v15, v[20:21] offset:13888
    s_waitcnt lgkmcnt(2)
    v_readfirstlane_b32 s60, v47
    v_readfirstlane_b32 s88, v45
    s_nop 0
    s_lshr_b32 s100, s88, 24
    s_sub_u32 s101, s100, 144
    s_sub_u32 s95, s100, 162
    s_lshr_b32 s68, s88, 5
    s_lshr_b32 s69, s88, 6
    s_and_b32 s68, s68, 8192
    s_and_b32 s69, s69, 8192
    s_lshr_b32 s62, s2, 4
    s_lshl_b32 s62, s62, 16
    s_and_b32 s63, s2, 15
    s_lshl_b32 s63, s63, 7
    s_add_u32 s33, s62, s63
    s_add_u32 s32, s33, s63
    s_add_u32 s33, s33, 2100224
    s_add_u32 s32, s32, 2097152
    v_mov_b32 v76, s68
    v_mov_b32 v77, s69
    v_cmp_gt_u32 vcc, 32, v2
    v_cndmask_b32 v77, v77, v76, vcc
    v_lshl_add_u32 v77, v5, 10, v77
    v_and_b32 v76, 15, v2
    v_lshl_add_u32 v76, v76, 4, v77
    s_cmp_lt_u32 s100, 144
    s_cbranch_scc1 L_tailD
    s_waitcnt lgkmcnt(0)
    s_cbranch_execz L_nobar1
    s_barrier
L_nobar1:
    s_cbranch_execz L_nobar2
    s_setprio 3
L_nobar2:
    s_cmp_lg_u32 s3, 0
    s_cbranch_scc1 L_Adone
    s_branch L_aspin_ok
L_tailD:
    s_cbranch_execz L_nobar3
    s_setprio 3
L_nobar3:
    s_cmp_eq_u32 s3, 0
    s_cbranch_scc1 L_aspin
    s_mov_b64 exec, 1
    ds_add_u32 v49, v50 offset:5648
    s_mov_b64 exec, -1
    s_branch L_bar1
L_aspin:
    ds_read_b32 v48, v49 offset:5648
    s_waitcnt lgkmcnt(0)
    v_readfirstlane_b32 s69, v48
    s_add_u32 s70, s70, 1
    s_cmp_ge_u32 s69, 7
    s_cbranch_scc1 L_aspin_ok
    s_cmp_lg_u32 s93, 0
    s_cbranch_scc1 L_aspin_ok
    s_cmp_lt_u32 s70, 8388608
    s_cbranch_scc1 L_aspin
L_aspin_ok:
    ds_read_b64 v[20:21], v14 offset:13888
    ds_read_b64 v[22:23], v14 offset:13904
    ds_read_b64 v[24:25], v14 offset:13920
    ds_read_b64 v[26:27], v14 offset:13936
    ds_read_b64 v[28:29], v14 offset:13952
    ds_read_b64 v[30:31], v14 offset:13968
    ds_read_b64 v[32:33], v14 offset:13984
    ds_read_b64 v[34:35], v14 offset:14000
    ds_read_b128 v[40:43], v6 offset:5696
    ds_read_b128 v[44:47], v6 offset:6720
    ds_read_b128 v[48:51], v6 offset:7744
    ds_read_b128 v[52:55], v6 offset:8768
    ds_read_b128 v[56:59], v6 offset:9792
    ds_read_b128 v[60:63], v6 offset:10816
    ds_read_b128 v[64:67], v6 offset:11840
    ds_read_b128 v[68:71], v6 offset:12864
    s_waitcnt lgkmcnt(8)
    v_max3_f32 v16, v20, v22, v24
    v_max3_f32 v18, v26, v28, v30
    v_max3_f32 v16, v16, v32, v34
    v_max_f32 v16, v16, v18
    v_sub_f32 v20, v20, v16
    v_sub_f32 v22, v22, v16
    v_sub_f32 v24, v24, v16
    v_sub_f32 v26, v26, v16
    v_sub_f32 v28, v28, v16
    v_sub_f32 v30, v30, v16
    v_sub_f32 v32, v32, v16
    v_sub_f32 v34, v34, v16
    v_exp_f32 v20, v20
    v_exp_f32 v22, v22
    v_exp_f32 v24, v24
    v_exp_f32 v26, v26
    v_exp_f32 v28, v28
    v_exp_f32 v30, v30
    v_exp_f32 v32, v32
    v_exp_f32 v34, v34
    v_mul_f32 v17, v20, v21
    v_mul_f32 v18, v22, v23
    v_fmac_f32 v17, v24, v25
    v_fmac_f32 v18, v26, v27
    v_fmac_f32 v17, v28, v29
    v_fmac_f32 v18, v30, v31
    v_fmac_f32 v17, v32, v33
    v_fmac_f32 v18, v34, v35
    s_waitcnt lgkmcnt(0)
    v_pk_mul_f32 v[36:37], v[40:41], v[20:21] op_sel_hi:[1,0]
    v_pk_mul_f32 v[72:73], v[44:45], v[22:23] op_sel_hi:[1,0]
    v_pk_mul_f32 v[38:39], v[42:43], v[20:21] op_sel_hi:[1,0]
    v_pk_mul_f32 v[74:75], v[46:47], v[22:23] op_sel_hi:[1,0]
    v_pk_fma_f32 v[36:37], v[48:49], v[24:25], v[36:37] op_sel_hi:[1,0,1]
    v_pk_fma_f32 v[38:39], v[50:51], v[24:25], v[38:39] op_sel_hi:[1,0,1]
    v_pk_fma_f32 v[72:73], v[52:53], v[26:27], v[72:73] op_sel_hi:[1,0,1]
    v_pk_fma_f32 v[74:75], v[54:55], v[26:27], v[74:75] op_sel_hi:[1,0,1]
    v_pk_fma_f32 v[36:37], v[56:57], v[28:29], v[36:37] op_sel_hi:[1,0,1]
    v_pk_fma_f32 v[38:39], v[58:59], v[28:29], v[38:39] op_sel_hi:[1,0,1]
    v_pk_fma_f32 v[72:73], v[60:61], v[30:31], v[72:73] op_sel_hi:[1,0,1]
    v_pk_fma_f32 v[74:75], v[62:63], v[30:31], v[74:75] op_sel_hi:[1,0,1]
    v_pk_fma_f32 v[36:37], v[64:65], v[32:33], v[36:37] op_sel_hi:[1,0,1]
    v_pk_fma_f32 v[38:39], v[66:67], v[32:33], v[38:39] op_sel_hi:[1,0,1]
    v_pk_fma_f32 v[72:73], v[68:69], v[34:35], v[72:73] op_sel_hi:[1,0,1]
    v_pk_fma_f32 v[74:75], v[70:71], v[34:35], v[74:75] op_sel_hi:[1,0,1]
    v_pk_add_f32 v[36:37], v[36:37], v[72:73]
    v_pk_add_f32 v[38:39], v[38:39], v[74:75]
    v_add_f32 v17, v17, v18
    v_mov_b32_sdwa v36, s60 dst_sel:BYTE_0 dst_unused:UNUSED_PRESERVE src0_sel:BYTE_0
    v_mov_b32_sdwa v37, s60 dst_sel:BYTE_0 dst_unused:UNUSED_PRESERVE src0_sel:BYTE_1
    v_mov_b32_sdwa v38, s60 dst_sel:BYTE_0 dst_unused:UNUSED_PRESERVE src0_sel:BYTE_2
    v_mov_b32_sdwa v39, s60 dst_sel:BYTE_0 dst_unused:UNUSED_PRESERVE src0_sel:BYTE_3
    s_cbranch_execz L_nov4
    buffer_store_dwordx4 v[36:39], v76, s[20:23], s32 offen sc1
L_nov4:
    s_mov_b32 s68, 0x10001
    s_mov_b32 s69, 0x10001
    v_mov_b32 v18, s60
    s_and_b64 exec, s[86:87], s[68:69]
    s_cbranch_execz L_nov5
    buffer_store_dwordx3 v[16:18], v77, s[20:23], s33 offen offset:1024 sc1
L_nov5:
    s_mov_b64 exec, s[86:87]
    s_cmp_ge_u32 s100, 144
    s_cbranch_scc1 L_Adone
L_bar1:
    s_waitcnt lgkmcnt(0)
    s_cbranch_execz L_nobar6
    s_barrier
L_nobar6:
    s_cbranch_execz L_nobar7
    s_setprio 3
L_nobar7:
L_Adone:
    s_cmp_lt_u32 s100, 144
    s_cbranch_scc1 L_stageD
    s_cmp_lt_u32 s101, 18
    s_cbranch_scc1 L_stageC
    s_cmp_ge_u32 s95, 4
    s_cbranch_scc1 L_end
    s_cmp_ge_u32 s3, 6
    s_cbranch_scc1 L_B_nopre
    s_cmp_ge_u32 s95, 4
    s_cbranch_scc1 L_pB_donet
    s_cmp_ge_u32 s3, 6
    s_cbranch_scc1 L_pB_donet
    v_bfe_u32 v14, v2, 2, 2
    v_lshrrev_b32 v15, 4, v2
    v_lshl_add_u32 v14, v15, 3, v14
    v_and_b32 v15, 3, v2
    s_movk_i32 s62, 1152
    v_mul_lo_u32 v16, v14, s62
    s_mul_i32 s62, s3, 192
    s_add_u32 s62, s62, 24640
    v_lshl_add_u32 v16, v15, 3, v16
    v_add_u32 v16, s62, v16
    ds_read_b64_tr_b16 v[80:81], v16 offset:0
    ds_read_b64_tr_b16 v[82:83], v16 offset:4608
    ds_read_b64_tr_b16 v[84:85], v16 offset:32
    ds_read_b64_tr_b16 v[86:87], v16 offset:4640
    ds_read_b64_tr_b16 v[88:89], v16 offset:64
    ds_read_b64_tr_b16 v[90:91], v16 offset:4672
    ds_read_b64_tr_b16 v[92:93], v16 offset:96
    ds_read_b64_tr_b16 v[94:95], v16 offset:4704
    ds_read_b64_tr_b16 v[96:97], v16 offset:128
    ds_read_b64_tr_b16 v[98:99], v16 offset:4736
    ds_read_b64_tr_b16 v[100:101], v16 offset:160
    ds_read_b64_tr_b16 v[102:103], v16 offset:4768
    ds_read_b64_tr_b16 v[104:105], v16 offset:36864
    ds_read_b64_tr_b16 v[106:107], v16 offset:41472
    ds_read_b64_tr_b16 v[108:109], v16 offset:36896
    ds_read_b64_tr_b16 v[110:111], v16 offset:41504
    ds_read_b64_tr_b16 v[112:113], v16 offset:36928
    ds_read_b64_tr_b16 v[114:115], v16 offset:41536
    ds_read_b64_tr_b16 v[116:117], v16 offset:36960
    ds_read_b64_tr_b16 v[118:119], v16 offset:41568
    ds_read_b64_tr_b16 v[120:121], v16 offset:36992
    ds_read_b64_tr_b16 v[122:123], v16 offset:41600
    ds_read_b64_tr_b16 v[124:125], v16 offset:37024
    ds_read_b64_tr_b16 v[126:127], v16 offset:41632
L_pB_donet:
L_B_nopre:
    v_lshlrev_b32 v19, 2, v2
    s_lshr_b32 s63, s2, 4
    s_lshl_b32 s71, s63, 2
    s_add_u32 s71, s71, s95
    v_and_b32 v46, 3, v2
    v_lshlrev_b32 v46, 3, v46
    v_bfe_u32 v46, s60, v46, 8
    s_lshl_b32 s71, s71, 7
    s_mul_i32 s62, s3, 3
    s_lshr_b32 s68, s88, s62
    s_bfe_u32 s47, s60, 0x1000d
    s_mul_i32 s62, s62, 16384
    s_add_u32 s71, s71, s62
    s_add_u32 s71, s71, 655360
    s_bfe_u32 s69, s68, 0x10002
    s_and_b32 s62, s68, 1
    s_sub_u32 s69, s69, s62
    s_lshl_b32 s69, s69, 13
    s_add_u32 s33, s71, s69
    s_add_u32 s33, s33, 32512
    v_lshrrev_b32 v20, 5, v2
    v_bfe_u32 v21, s68, v20, 1
    v_mul_u32_u24 v20, 16384, v20
    v_and_b32 v19, 31, v2
    v_lshl_add_u32 v19, v19, 2, v20
    v_lshl_add_u32 v19, v21, 13, v19
    s_cmp_eq_u32 s3, 6
    s_cselect_b32 s62, 1, s93
    s_cmp_eq_u32 s62, 0
    s_cbranch_scc1 L_B_bar
    v_lshlrev_b32 v15, 7, v5
    v_and_b32 v16, 15, v2
    v_lshl_add_u32 v14, v16, 4, v15
    v_lshrrev_b32 v17, 3, v5
    v_lshl_add_u32 v16, v16, 3, v17
    s_lshl_b32 s63, s63, 15
    s_add_u32 s63, s63, 2097152
    s_lshl_b32 s62, s95, 8
    s_add_u32 s72, s63, s62
    s_lshl_b32 s62, s95, 7
    s_add_u32 s76, s63, s62
    s_lshr_b32 s62, s2, 4
    s_lshl_b32 s62, s62, 2
    s_add_u32 s62, s62, s95
    s_lshl_b32 s62, s62, 14
    s_lshr_b32 s63, s95, 1
    s_add_u32 s63, s63, 5
    s_lshr_b32 s63, s88, s63
    s_and_b32 s63, s63, 8192
    s_add_u32 s72, s62, s63
    s_add_u32 s72, s72, 2097152
    s_add_u32 s76, s72, 3072
    v_mov_b32 v14, v6
    v_lshlrev_b32 v15, 3, v5
    s_add_u32 s73, s72, 1024
    s_add_u32 s77, s76, 512
    s_add_u32 s74, s72, 2048
    s_add_u32 s78, s76, 1024
    s_add_u32 s75, s72, 3072
    s_add_u32 s79, s76, 1536
    s_mov_b64 s[12:13], s[86:87]
    s_mov_b64 s[14:15], s[86:87]
    s_mov_b64 s[16:17], s[86:87]
    s_mov_b64 s[18:19], s[86:87]
    v_mov_b32 v196, -1
    v_mov_b32 v197, -1
    v_mov_b32 v198, -1
    v_mov_b32 v199, -1
    v_mov_b32 v200, -1
    v_mov_b32 v201, -1
    v_mov_b32 v202, -1
    v_mov_b32 v203, -1
    v_mov_b32 v204, -1
    v_mov_b32 v205, -1
    v_mov_b32 v206, -1
    v_mov_b32 v207, -1
    v_mov_b32 v208, -1
    v_mov_b32 v209, -1
    v_mov_b32 v210, -1
    v_mov_b32 v211, -1
    v_mov_b32 v212, -1
    v_mov_b32 v213, -1
    v_mov_b32 v214, -1
    v_mov_b32 v215, -1
    v_mov_b32 v216, -1
    v_mov_b32 v217, -1
    v_mov_b32 v218, -1
    v_mov_b32 v219, -1
    v_mov_b32 v220, -1
    v_mov_b32 v221, -1
    v_mov_b32 v222, -1
    v_mov_b32 v223, -1
    v_mov_b32 v224, -1
    v_mov_b32 v225, -1
    v_mov_b32 v226, -1
    v_mov_b32 v227, -1
    s_mov_b32 s70, 0
    s_branch L_pollB
L_pollB_pre:
    s_sleep 2
L_pollB:
    s_mov_b64 exec, s[12:13]
    s_cmp_lg_u32 s93, 0
    s_cbranch_scc1 L_nov8
    buffer_load_dwordx4 v[196:199], v14, s[20:23], s72 offen sc1
    buffer_load_dwordx3 v[212:214], v15, s[20:23], s76 offen offset:1024 sc1
L_nov8:
    s_mov_b64 exec, s[14:15]
    s_cmp_lg_u32 s93, 0
    s_cbranch_scc1 L_nov9
    buffer_load_dwordx4 v[200:203], v14, s[20:23], s73 offen sc1
    buffer_load_dwordx3 v[216:218], v15, s[20:23], s77 offen offset:1024 sc1
L_nov9:
    s_mov_b64 exec, s[16:17]
    s_cmp_lg_u32 s93, 0
    s_cbranch_scc1 L_nov10
    buffer_load_dwordx4 v[204:207], v14, s[20:23], s74 offen sc1
    buffer_load_dwordx3 v[220:222], v15, s[20:23], s78 offen offset:1024 sc1
L_nov10:
    s_mov_b64 exec, s[18:19]
    s_cmp_lg_u32 s93, 0
    s_cbranch_scc1 L_nov11
    buffer_load_dwordx4 v[208:211], v14, s[20:23], s75 offen sc1
    buffer_load_dwordx3 v[224:226], v15, s[20:23], s79 offen offset:1024 sc1
L_nov11:
    s_mov_b64 exec, s[86:87]
    s_add_u32 s70, s70, 1
    s_cmp_lt_u32 s70, 2
    s_cbranch_scc1 L_pollB_pre
    s_waitcnt vmcnt(8)
    v_cmp_ne_u32 s[24:25], s60, v214
    v_cmp_ne_u32 s[26:27], s60, v218
    v_cmp_ne_u32 s[28:29], s60, v222
    v_cmp_ne_u32 s[30:31], s60, v226
    v_perm_b32 v20, v197, v196, s44
    v_perm_b32 v21, v199, v198, s45
    v_perm_b32 v22, v201, v200, s44
    v_perm_b32 v23, v203, v202, s45
    v_perm_b32 v24, v205, v204, s44
    v_perm_b32 v25, v207, v206, s45
    v_perm_b32 v26, v209, v208, s44
    v_perm_b32 v27, v211, v210, s45
    v_or_b32 v20, v20, v21
    v_or_b32 v22, v22, v23
    v_or_b32 v24, v24, v25
    v_or_b32 v26, v26, v27
    v_cmp_ne_u32 s[12:13], s60, v20
    v_cmp_ne_u32 s[14:15], s60, v22
    v_cmp_ne_u32 s[16:17], s60, v24
    v_cmp_ne_u32 s[18:19], s60, v26
    s_or_b64 s[12:13], s[12:13], s[24:25]
    s_or_b64 s[14:15], s[14:15], s[26:27]
    s_or_b64 s[16:17], s[16:17], s[28:29]
    s_or_b64 s[18:19], s[18:19], s[30:31]
    s_or_b64 s[80:81], s[12:13], s[14:15]
    s_or_b64 s[82:83], s[16:17], s[18:19]
    s_or_b64 s[80:81], s[80:81], s[82:83]
    s_cbranch_scc0 L_pollB_done
    s_cmp_lt_u32 s70, 20000
    s_cbranch_scc1 L_pollB
L_pollB_done:
    v_max3_f32 v20, v212, v216, v220
    v_max_f32 v20, v20, v224
    v_mov_b32 v21, v20
    s_nop 1
    v_permlane32_swap_b32 v20, v21
    s_nop 0
    v_max_f32 v20, v20, v21
    v_mov_b32 v21, v20
    s_nop 1
    v_permlane16_swap_b32 v20, v21
    s_nop 0
    v_max_f32 v20, v20, v21
    v_sub_f32 v22, v212, v20
    v_sub_f32 v24, v216, v20
    v_sub_f32 v26, v220, v20
    v_sub_f32 v28, v224, v20
    v_exp_f32 v22, v22
    v_exp_f32 v24, v24
    v_exp_f32 v26, v26
    v_exp_f32 v28, v28
    v_mul_f32 v30, v213, v22
    v_pk_mul_f32 v[32:33], v[196:197], v[22:23] op_sel_hi:[1,0]
    v_pk_mul_f32 v[34:35], v[198:199], v[22:23] op_sel_hi:[1,0]
    v_fmac_f32 v30, v217, v24
    v_pk_fma_f32 v[32:33], v[200:201], v[24:25], v[32:33] op_sel_hi:[1,0,1]
    v_pk_fma_f32 v[34:35], v[202:203], v[24:25], v[34:35] op_sel_hi:[1,0,1]
    v_fmac_f32 v30, v221, v26
    v_pk_fma_f32 v[32:33], v[204:205], v[26:27], v[32:33] op_sel_hi:[1,0,1]
    v_pk_fma_f32 v[34:35], v[206:207], v[26:27], v[34:35] op_sel_hi:[1,0,1]
    v_fmac_f32 v30, v225, v28
    v_pk_fma_f32 v[32:33], v[208:209], v[28:29], v[32:33] op_sel_hi:[1,0,1]
    v_pk_fma_f32 v[34:35], v[210:211], v[28:29], v[34:35] op_sel_hi:[1,0,1]
    v_mov_b32 v31, v30
    s_nop 0
    v_permlane32_swap_b32 v32, v34
    v_permlane32_swap_b32 v30, v31
    v_permlane32_swap_b32 v33, v35
    v_add_f32 v30, v30, v31
    v_add_f32 v32, v32, v34
    v_mov_b32 v31, v30
    v_add_f32 v33, v33, v35
    s_nop 0
    v_permlane16_swap_b32 v30, v31
    v_permlane16_swap_b32 v32, v33
    v_add_f32 v30, v30, v31
    v_rcp_f32 v30, v30
    v_add_f32 v32, v32, v33
    v_mul_f32 v32, v32, v30
    v_cvt_pk_bf16_f32 v32, v32, v32
    ds_write_b16 v16, v32 offset:14016
L_B_bar:
    s_waitcnt lgkmcnt(0)
    s_cbranch_execz L_nobar12
    s_barrier
L_nobar12:
    s_cmp_ge_u32 s3, 6
    s_cbranch_scc1 L_end
    ds_read_b128 v[20:23], v5 offset:14016
    ds_read_b128 v[24:27], v5 offset:14080
    s_waitcnt lgkmcnt(1)
    v_mfma_f32_16x16x32_bf16 v[160:163], v[20:23], v[80:83], 0
    v_mfma_f32_16x16x32_bf16 v[164:167], v[20:23], v[84:87], 0
    v_mfma_f32_16x16x32_bf16 v[168:171], v[20:23], v[88:91], 0
    v_mfma_f32_16x16x32_bf16 v[172:175], v[20:23], v[92:95], 0
    v_mfma_f32_16x16x32_bf16 v[176:179], v[20:23], v[96:99], 0
    v_mfma_f32_16x16x32_bf16 v[180:183], v[20:23], v[100:103], 0
    s_waitcnt lgkmcnt(0)
    v_mfma_f32_16x16x32_bf16 v[160:163], v[24:27], v[104:107], v[160:163]
    v_mfma_f32_16x16x32_bf16 v[164:167], v[24:27], v[108:111], v[164:167]
    v_mfma_f32_16x16x32_bf16 v[168:171], v[24:27], v[112:115], v[168:171]
    v_mfma_f32_16x16x32_bf16 v[172:175], v[24:27], v[116:119], v[172:175]
    v_mfma_f32_16x16x32_bf16 v[176:179], v[24:27], v[120:123], v[176:179]
    v_mfma_f32_16x16x32_bf16 v[180:183], v[24:27], v[124:127], v[180:183]
    s_nop 2
    v_mov_b32_dpp v160, v164 quad_perm:[0,1,2,3] row_mask:0x2 bank_mask:0xf
    s_nop 0
    v_mov_b32_dpp v160, v168 quad_perm:[0,1,2,3] row_mask:0x4 bank_mask:0xf
    s_nop 0
    v_mov_b32_dpp v160, v172 quad_perm:[0,1,2,3] row_mask:0x8 bank_mask:0xf
    v_and_or_b32 v160, v160, s46, v46
    s_cbranch_execz L_nov13
    buffer_store_dword v160, v19, s[20:23], s71 offen sc1
L_nov13:
    s_nop 3
    v_mov_b32_dpp v176, v180 quad_perm:[0,1,2,3] row_mask:0x2 bank_mask:0xf
    v_and_or_b32 v176, v176, s46, v46
    s_mov_b32 exec_hi, 0
    s_cbranch_execz L_nov14
    buffer_store_dword v176, v19, s[20:23], s33 offen offset:256 sc1
L_nov14:
    s_mov_b64 exec, s[86:87]
    s_branch L_end
L_stageC:
    v_lshrrev_b32 v14, 3, v2
    s_movk_i32 s62, 2304
    v_mul_lo_u32 v14, v14, s62
    v_and_b32 v15, 7, v2
    v_lshl_add_u32 v14, v15, 4, v14
    s_lshl_b32 s63, s101, 7
    s_mul_i32 s84, s3, 41472
    s_add_u32 s84, s84, s63
    s_add_u32 s84, s84, 3670016
    s_add_u32 s85, s84, 18432
    s_add_u32 s69, s84, 36864
    v_cmp_gt_u32 vcc, 16, v2
    v_lshlrev_b32 v17, 5, v248
    s_lshl_b32 s68, s3, 2
    v_add_u32 v16, s68, v17
    v_lshlrev_b32 v41, 1, v248
    s_lshr_b32 s62, s88, s101
    s_bfe_u32 s47, s60, 0x1000d
    s_and_b32 s62, s62, 1
    s_lshl_b32 s74, s62, 13
    s_mul_i32 s84, s101, 49152
    s_add_u32 s84, s84, s74
    s_add_u32 s84, s84, 983040
    s_lshl_b32 s62, s3, 8
    s_add_u32 s69, s84, s62
    s_add_u32 s69, s69, 32768
    s_lshl_b32 s62, s3, 10
    s_add_u32 s84, s84, s62
    s_add_u32 s85, s84, 16384
    v_mov_b32 v96, -1
    v_mov_b32 v97, -1
    v_mov_b32 v98, -1
    v_mov_b32 v99, -1
    v_mov_b32 v100, -1
    v_mov_b32 v101, -1
    v_mov_b32 v102, -1
    v_mov_b32 v103, -1
    v_cndmask_b32 v104, 0, -1, vcc
    v_cndmask_b32 v105, 0, -1, vcc
    v_cndmask_b32 v106, 0, -1, vcc
    v_cndmask_b32 v107, 0, -1, vcc
    s_cmp_eq_u32 s3, 6
    s_cselect_b32 s62, 1, s93
    s_cmp_eq_u32 s62, 0
    s_cbranch_scc1 L_E_bar
    s_add_u32 s72, s63, 1916928
    v_lshlrev_b32 v42, 16, v250
    v_lshlrev_b32 v43, 16, v251
    v_bfe_u32 v19, v2, 3, 2
    s_movk_i32 s62, 2304
    v_mul_lo_u32 v19, v19, s62
    v_lshl_add_u32 v19, v15, 4, v19
    v_lshrrev_b32 v20, 5, v2
    v_lshl_add_u32 v19, v20, 3, v19
    s_lshl_b32 s71, s101, 6
    s_add_u32 s32, s63, 2064384
    s_add_u32 s33, s32, 9216
    s_mov_b32 s70, 0
    s_lshl_b32 s72, s101, 14
    s_add_u32 s72, s72, s74
    s_add_u32 s72, s72, 655360
    v_bfe_u32 v19, v2, 3, 1
    v_lshlrev_b32 v19, 12, v19
    v_bfe_u32 v21, v2, 4, 1
    v_lshl_add_u32 v19, v21, 14, v19
    v_lshl_add_u32 v19, v15, 4, v19
    v_lshl_add_u32 v19, v20, 3, v19
    s_add_u32 s32, s63, 950272
    s_lshl_b32 s62, s47, 13
    s_add_u32 s32, s32, s62
    s_xor_b32 s33, s32, 8192
    s_add_u32 s73, s72, 1024
    s_add_u32 s74, s72, 2048
    s_add_u32 s75, s72, 3072
    s_add_u32 s76, s72, 4096
    s_add_u32 s77, s72, 5120
    s_add_u32 s78, s72, 6144
    s_add_u32 s79, s72, 7168
    s_mov_b64 s[12:13], s[86:87]
    s_mov_b64 s[14:15], s[86:87]
    s_mov_b64 s[16:17], s[86:87]
    s_mov_b64 s[18:19], s[86:87]
    s_mov_b64 s[24:25], s[86:87]
    s_mov_b64 s[26:27], s[86:87]
    s_mov_b64 s[28:29], s[86:87]
    s_mov_b64 s[30:31], s[86:87]
    v_mov_b32 v64, -1
    v_mov_b32 v65, -1
    v_mov_b32 v66, -1
    v_mov_b32 v67, -1
    v_mov_b32 v68, -1
    v_mov_b32 v69, -1
    v_mov_b32 v70, -1
    v_mov_b32 v71, -1
    v_mov_b32 v72, -1
    v_mov_b32 v73, -1
    v_mov_b32 v74, -1
    v_mov_b32 v75, -1
    v_mov_b32 v76, -1
    v_mov_b32 v77, -1
    v_mov_b32 v78, -1
    v_mov_b32 v79, -1
    v_mov_b32 v80, -1
    v_mov_b32 v81, -1
    v_mov_b32 v82, -1
    v_mov_b32 v83, -1
    v_mov_b32 v84, -1
    v_mov_b32 v85, -1
    v_mov_b32 v86, -1
    v_mov_b32 v87, -1
    v_mov_b32 v88, -1
    v_mov_b32 v89, -1
    v_mov_b32 v90, -1
    v_mov_b32 v91, -1
    v_mov_b32 v92, -1
    v_mov_b32 v93, -1
    v_mov_b32 v94, -1
    v_mov_b32 v95, -1
    s_sleep 16
    s_mov_b32 s70, 0
    s_branch L_pollC
L_pollC_pre:
    s_sleep 2
L_pollC:
    s_mov_b64 exec, s[12:13]
    s_cmp_lg_u32 s93, 0
    s_cbranch_scc1 L_nov15
    buffer_load_dwordx4 v[64:67], v6, s[20:23], s72 offen sc1
L_nov15:
    s_mov_b64 exec, s[14:15]
    s_cmp_lg_u32 s93, 0
    s_cbranch_scc1 L_nov16
    buffer_load_dwordx4 v[68:71], v6, s[20:23], s73 offen sc1
L_nov16:
    s_mov_b64 exec, s[16:17]
    s_cmp_lg_u32 s93, 0
    s_cbranch_scc1 L_nov17
    buffer_load_dwordx4 v[72:75], v6, s[20:23], s74 offen sc1
L_nov17:
    s_mov_b64 exec, s[18:19]
    s_cmp_lg_u32 s93, 0
    s_cbranch_scc1 L_nov18
    buffer_load_dwordx4 v[76:79], v6, s[20:23], s75 offen sc1
L_nov18:
    s_mov_b64 exec, s[24:25]
    s_cmp_lg_u32 s93, 0
    s_cbranch_scc1 L_nov19
    buffer_load_dwordx4 v[80:83], v6, s[20:23], s76 offen sc1
L_nov19:
    s_mov_b64 exec, s[26:27]
    s_cmp_lg_u32 s93, 0
    s_cbranch_scc1 L_nov20
    buffer_load_dwordx4 v[84:87], v6, s[20:23], s77 offen sc1
L_nov20:
    s_mov_b64 exec, s[28:29]
    s_cmp_lg_u32 s93, 0
    s_cbranch_scc1 L_nov21
    buffer_load_dwordx4 v[88:91], v6, s[20:23], s78 offen sc1
L_nov21:
    s_mov_b64 exec, s[30:31]
    s_cmp_lg_u32 s93, 0
    s_cbranch_scc1 L_nov22
    buffer_load_dwordx4 v[92:95], v6, s[20:23], s79 offen sc1
L_nov22:
    s_mov_b64 exec, s[86:87]
    s_add_u32 s70, s70, 1
    s_cmp_lt_u32 s70, 2
    s_cbranch_scc1 L_pollC_pre
    s_waitcnt vmcnt(8)
    v_perm_b32 v20, v65, v64, s44
    v_perm_b32 v21, v67, v66, s45
    v_perm_b32 v22, v69, v68, s44
    v_perm_b32 v23, v71, v70, s45
    v_perm_b32 v24, v73, v72, s44
    v_perm_b32 v25, v75, v74, s45
    v_perm_b32 v26, v77, v76, s44
    v_perm_b32 v27, v79, v78, s45
    v_perm_b32 v28, v81, v80, s44
    v_perm_b32 v29, v83, v82, s45
    v_perm_b32 v30, v85, v84, s44
    v_perm_b32 v31, v87, v86, s45
    v_perm_b32 v32, v89, v88, s44
    v_perm_b32 v33, v91, v90, s45
    v_perm_b32 v34, v93, v92, s44
    v_perm_b32 v35, v95, v94, s45
    v_or_b32 v20, v20, v21
    v_or_b32 v22, v22, v23
    v_or_b32 v24, v24, v25
    v_or_b32 v26, v26, v27
    v_or_b32 v28, v28, v29
    v_or_b32 v30, v30, v31
    v_or_b32 v32, v32, v33
    v_or_b32 v34, v34, v35
    v_cmp_ne_u32 s[12:13], s60, v20
    v_cmp_ne_u32 s[14:15], s60, v22
    v_cmp_ne_u32 s[16:17], s60, v24
    v_cmp_ne_u32 s[18:19], s60, v26
    v_cmp_ne_u32 s[24:25], s60, v28
    v_cmp_ne_u32 s[26:27], s60, v30
    v_cmp_ne_u32 s[28:29], s60, v32
    v_cmp_ne_u32 s[30:31], s60, v34
    s_or_b64 s[80:81], s[12:13], s[14:15]
    s_or_b64 s[82:83], s[16:17], s[18:19]
    s_or_b64 s[80:81], s[80:81], s[24:25]
    s_or_b64 s[82:83], s[82:83], s[26:27]
    s_or_b64 s[80:81], s[80:81], s[28:29]
    s_or_b64 s[82:83], s[82:83], s[30:31]
    s_or_b64 s[80:81], s[80:81], s[82:83]
    s_cbranch_scc0 L_pollC_done
    s_cmp_lt_u32 s70, 20000
    s_cbranch_scc1 L_pollC
L_pollC_done:
    v_pk_add_f32 v[20:21], v[64:65], v[68:69]
    v_pk_add_f32 v[22:23], v[66:67], v[70:71]
    v_pk_add_f32 v[24:25], v[72:73], v[76:77]
    v_pk_add_f32 v[26:27], v[74:75], v[78:79]
    v_pk_add_f32 v[28:29], v[80:81], v[84:85]
    v_pk_add_f32 v[30:31], v[82:83], v[86:87]
    v_pk_add_f32 v[32:33], v[88:89], v[92:93]
    v_pk_add_f32 v[34:35], v[90:91], v[94:95]
    v_pk_add_f32 v[20:21], v[20:21], v[24:25]
    v_pk_add_f32 v[22:23], v[22:23], v[26:27]
    v_pk_add_f32 v[28:29], v[28:29], v[32:33]
    v_pk_add_f32 v[30:31], v[30:31], v[34:35]
    v_pk_add_f32 v[20:21], v[20:21], v[28:29]
    v_pk_add_f32 v[22:23], v[22:23], v[30:31]
    s_nop 0
    v_add_f32_dpp v20, v20, v20 row_ror:8 row_mask:0xf bank_mask:0xf
    v_add_f32_dpp v21, v21, v21 row_ror:8 row_mask:0xf bank_mask:0xf
    v_add_f32_dpp v22, v22, v22 row_ror:8 row_mask:0xf bank_mask:0xf
    v_add_f32_dpp v23, v23, v23 row_ror:8 row_mask:0xf bank_mask:0xf
    s_nop 0
    v_permlane32_swap_b32 v20, v22
    v_permlane32_swap_b32 v21, v23
    s_nop 0
    v_add_f32 v20, v20, v22
    v_add_f32 v21, v21, v23
    s_nop 1
    v_permlane16_swap_b32 v20, v21
    s_nop 0
    v_add_f32 v20, v20, v21
    v_cvt_pk_bf16_f32 v20, v20, v20
    v_lshlrev_b32 v20, 16, v20
    v_add_f32 v44, v42, v20
    v_cvt_pk_bf16_f32 v44, v44, v44
    v_lshlrev_b32 v44, 16, v44
    v_mov_b32 v20, v44
    v_mov_b32 v21, v44
    s_nop 1
    v_permlane16_swap_b32 v20, v21
    s_nop 0
    v_cvt_pk_bf16_f32 v20, v20, v21
    v_mov_b32 v21, s60
    s_cbranch_execz L_nov23
    buffer_store_dwordx2 v[20:21], v19, s[20:23], s32 offen sc1
    buffer_store_dwordx2 v[20:21], v19, s[20:23], s33 offen sc1
L_nov23:
    s_sleep 24
L_E_bar:
    s_mov_b64 s[12:13], s[86:87]
    s_mov_b64 s[14:15], s[86:87]
    s_and_b64 s[16:17], s[86:87], 0xffff
    s_cbranch_execz L_nobar24
    s_barrier
L_nobar24:
    s_mov_b32 s70, 0
    s_branch L_pollE
L_pollE_pre:
    s_sleep 2
L_pollE:
    s_mov_b64 exec, s[12:13]
    s_cmp_lg_u32 s93, 0
    s_cbranch_scc1 L_nov25
    buffer_load_dwordx4 v[96:99], v6, s[20:23], s84 offen sc1
L_nov25:
    s_mov_b64 exec, s[14:15]
    s_cmp_lg_u32 s93, 0
    s_cbranch_scc1 L_nov26
    buffer_load_dwordx4 v[100:103], v6, s[20:23], s85 offen sc1
L_nov26:
    s_mov_b64 exec, s[16:17]
    s_cmp_lg_u32 s93, 0
    s_cbranch_scc1 L_nov27
    buffer_load_dwordx4 v[104:107], v6, s[20:23], s69 offen sc1
L_nov27:
    s_mov_b64 exec, s[86:87]
    s_add_u32 s70, s70, 1
    s_cmp_lt_u32 s70, 2
    s_cbranch_scc1 L_pollE_pre
    s_waitcnt vmcnt(3)
    v_perm_b32 v20, v97, v96, s44
    v_perm_b32 v21, v99, v98, s45
    v_perm_b32 v22, v101, v100, s44
    v_perm_b32 v23, v103, v102, s45
    v_perm_b32 v24, v105, v104, s44
    v_perm_b32 v25, v107, v106, s45
    v_or_b32 v20, v20, v21
    v_or_b32 v22, v22, v23
    v_or_b32 v24, v24, v25
    v_cmp_ne_u32 s[12:13], s60, v20
    v_cmp_ne_u32 s[14:15], s60, v22
    v_cmp_ne_u32 s[16:17], s60, v24
    s_or_b64 s[80:81], s[12:13], s[14:15]
    s_and_b64 s[16:17], s[16:17], 0xffff
    s_or_b64 s[80:81], s[80:81], s[16:17]
    s_cbranch_scc0 L_pollE_done
    s_cmp_lt_u32 s70, 20000
    s_cbranch_scc1 L_pollE
L_pollE_done:
    v_pk_add_f32 v[20:21], v[96:97], v[100:101]
    v_pk_add_f32 v[22:23], v[98:99], v[102:103]
    v_pk_add_f32 v[20:21], v[20:21], v[104:105]
    v_pk_add_f32 v[22:23], v[22:23], v[106:107]
    s_nop 0
    v_add_f32_dpp v20, v20, v20 row_ror:8 row_mask:0xf bank_mask:0xf
    v_add_f32_dpp v21, v21, v21 row_ror:8 row_mask:0xf bank_mask:0xf
    v_add_f32_dpp v22, v22, v22 row_ror:8 row_mask:0xf bank_mask:0xf
    v_add_f32_dpp v23, v23, v23 row_ror:8 row_mask:0xf bank_mask:0xf
    s_nop 0
    v_permlane32_swap_b32 v20, v22
    v_permlane32_swap_b32 v21, v23
    s_nop 0
    v_add_f32 v20, v20, v22
    v_add_f32 v21, v21, v23
    s_nop 1
    v_permlane16_swap_b32 v20, v21
    s_nop 0
    v_add_f32 v20, v20, v21
    ds_write_b32 v16, v20 offset:20288
    s_waitcnt lgkmcnt(0)
    s_cbranch_execz L_nobar28
    s_barrier
L_nobar28:
    s_cmp_eq_u32 s3, 6
    s_cselect_b32 s62, 1, s93
    s_cmp_eq_u32 s62, 0
    s_cbranch_scc1 L_end
    ds_read_b128 v[20:23], v17 offset:20288
    ds_read_b128 v[24:27], v17 offset:20304
    s_mov_b32 s68, 0x00ff00ff
    s_mov_b32 s69, 0x00ff00ff
    s_waitcnt lgkmcnt(0)
    v_pk_add_f32 v[20:21], v[20:21], v[22:23]
    v_pk_add_f32 v[24:25], v[24:25], v[26:27]
    v_pk_add_f32 v[20:21], v[20:21], v[24:25]
    v_add_f32 v20, v20, v21
    v_cvt_pk_bf16_f32 v20, v20, v20
    v_lshlrev_b32 v20, 16, v20
    v_add_f32 v20, v20, v43
    v_cvt_pk_bf16_f32 v20, v20, v20
    v_lshlrev_b32 v20, 16, v20
    v_add_f32 v20, v20, v44
    v_cvt_pk_bf16_f32 v20, v20, v20
    s_and_b64 exec, s[86:87], s[68:69]
    s_cbranch_execz L_nov29
    buffer_store_short v20, v41, s[52:55], s71 offen
L_nov29:
    s_mov_b64 exec, s[86:87]
    s_branch L_end
L_stageD:
    s_cmp_ge_u32 s100, 144
    s_cbranch_scc1 L_pD_donet
    s_cmp_ge_u32 s3, 6
    s_cbranch_scc1 L_pD_donet
    v_bfe_u32 v14, v2, 2, 2
    v_lshrrev_b32 v15, 4, v2
    v_lshl_add_u32 v14, v15, 3, v14
    v_and_b32 v15, 3, v2
    s_movk_i32 s62, 1152
    v_mul_lo_u32 v16, v14, s62
    s_mul_i32 s62, s3, 192
    s_add_u32 s62, s62, 61504
    v_lshl_add_u32 v16, v15, 3, v16
    v_add_u32 v16, s62, v16
    ds_read_b64_tr_b16 v[104:105], v16 offset:0
    ds_read_b64_tr_b16 v[106:107], v16 offset:4608
    ds_read_b64_tr_b16 v[108:109], v16 offset:32
    ds_read_b64_tr_b16 v[110:111], v16 offset:4640
    ds_read_b64_tr_b16 v[112:113], v16 offset:64
    ds_read_b64_tr_b16 v[114:115], v16 offset:4672
    ds_read_b64_tr_b16 v[116:117], v16 offset:96
    ds_read_b64_tr_b16 v[118:119], v16 offset:4704
    ds_read_b64_tr_b16 v[120:121], v16 offset:128
    ds_read_b64_tr_b16 v[122:123], v16 offset:4736
    ds_read_b64_tr_b16 v[124:125], v16 offset:160
    ds_read_b64_tr_b16 v[126:127], v16 offset:4768
    s_mul_i32 s62, s3, 96
    v_add3_u32 v14, s62, v14, v5
    v_lshlrev_b32 v14, 6, v14
    v_lshl_add_u32 v14, v15, 3, v14
    v_add_u32 v14, 24640, v14
    ds_read_b64_tr_b16 v[80:81], v14 offset:0
    ds_read_b64_tr_b16 v[82:83], v14 offset:256
    ds_read_b64_tr_b16 v[84:85], v14 offset:32
    ds_read_b64_tr_b16 v[86:87], v14 offset:288
    ds_read_b64_tr_b16 v[88:89], v14 offset:512
    ds_read_b64_tr_b16 v[90:91], v14 offset:768
    ds_read_b64_tr_b16 v[92:93], v14 offset:544
    ds_read_b64_tr_b16 v[94:95], v14 offset:800
    ds_read_b64_tr_b16 v[96:97], v14 offset:1024
    ds_read_b64_tr_b16 v[98:99], v14 offset:1280
    ds_read_b64_tr_b16 v[100:101], v14 offset:1056
    ds_read_b64_tr_b16 v[102:103], v14 offset:1312
    v_mov_b32 v20, 0x3f803f80
    v_mov_b32 v21, 0x3f803f80
    v_mov_b32 v22, 0x3f803f80
    v_mov_b32 v23, 0x3f803f80
    s_lshl_b32 s62, s3, 8
    v_lshlrev_b32 v15, 2, v2
    v_add_u32 v15, s62, v15
    s_waitcnt lgkmcnt(0)
    v_mfma_f32_16x16x32_bf16 v[24:27], v[20:23], v[80:83], 0
    v_mfma_f32_16x16x32_bf16 v[28:31], v[20:23], v[84:87], 0
    v_mfma_f32_16x16x32_bf16 v[24:27], v[20:23], v[88:91], v[24:27]
    v_mfma_f32_16x16x32_bf16 v[28:31], v[20:23], v[92:95], v[28:31]
    v_mfma_f32_16x16x32_bf16 v[24:27], v[20:23], v[96:99], v[24:27]
    v_mfma_f32_16x16x32_bf16 v[28:31], v[20:23], v[100:103], v[28:31]
    s_nop 7
    s_nop 1
    v_mov_b32_dpp v24, v28 quad_perm:[0,1,2,3] row_mask:0x2 bank_mask:0xf
    ds_write_b32 v15, v24 offset:18240
L_pD_donet:
    s_waitcnt lgkmcnt(0)
L_D_nopre:
    s_lshl_b32 s62, s3, 9
    v_lshlrev_b32 v19, 2, v2
    v_lshlrev_b32 v17, 3, v2
    v_add_u32 v17, s62, v17
    v_and_b32 v20, 7, v2
    v_lshrrev_b32 v21, 1, v5
    v_add_u32 v16, v20, v21
    v_and_b32 v18, 15, v16
    v_lshlrev_b32 v18, 3, v18
    v_lshrrev_b32 v21, 5, v2
    v_lshl_add_u32 v18, v21, 2, v18
    v_lshlrev_b32 v16, 2, v16
    v_and_b32 v14, 3, v2
    s_mov_b32 s82, 0x00770077
    s_mov_b32 s83, 0x00770077
    s_and_b64 s[82:83], s[82:83], s[86:87]
    v_lshrrev_b32 v21, 4, v2
    v_mul_u32_u24 v21, 3, v21
    v_add_u32 v14, v14, v21
    v_lshlrev_b32 v14, 5, v14
    v_bfe_u32 v21, v2, 2, 1
    v_lshl_add_u32 v14, v21, 4, v14
    v_mov_b32 v45, s60
    v_and_b32 v46, 3, v2
    v_lshlrev_b32 v46, 3, v46
    v_bfe_u32 v46, s60, v46, 8
    v_mov_b32 v36, 0
    v_lshlrev_b32 v61, 16, v249
    s_mul_i32 s71, s100, 2304
    s_mul_i32 s62, s3, 384
    s_add_u32 s71, s71, s62
    s_add_u32 s71, s71, 3670016
    s_and_b32 s72, s2, 7
    s_mul_i32 s72, s72, 2304
    s_add_u32 s72, s72, 2064384
    s_mov_b32 s33, s71
    s_getreg_b32 s73, hwreg(HW_REG_XCC_ID, 0, 3)
    s_and_b32 s72, s73, 1
    s_lshl_b32 s72, s72, 12
    s_and_b32 s62, s73, 2
    s_lshl_b32 s62, s62, 13
    s_add_u32 s72, s72, s62
    s_bfe_u32 s62, s73, 0x10002
    s_bfe_u32 s47, s60, 0x1000d
    s_xor_b32 s62, s62, s47
    s_lshl_b32 s62, s62, 13
    s_add_u32 s72, s72, s62
    s_add_u32 s72, s72, 950272
    s_lshr_b32 s71, s100, 6
    s_lshl_b32 s71, s71, 14
    s_and_b32 s62, s100, 63
    s_lshl_b32 s62, s62, 7
    s_add_u32 s71, s71, s62
    s_mul_i32 s62, s3, 3
    s_lshr_b32 s68, s88, s62
    s_bfe_u32 s47, s60, 0x1000d
    s_mul_i32 s62, s62, 49152
    s_add_u32 s71, s71, s62
    s_add_u32 s71, s71, 983040
    s_bfe_u32 s69, s68, 0x10002
    s_and_b32 s62, s68, 1
    s_sub_u32 s69, s69, s62
    s_lshl_b32 s69, s69, 13
    s_add_u32 s33, s71, s69
    s_add_u32 s33, s33, 98048
    v_lshrrev_b32 v20, 5, v2
    v_bfe_u32 v21, s68, v20, 1
    v_mul_u32_u24 v20, 49152, v20
    v_and_b32 v19, 31, v2
    v_lshl_add_u32 v19, v19, 2, v20
    v_lshl_add_u32 v19, v21, 13, v19
    s_mul_i32 s73, s3, 384
    s_add_u32 s73, s73, s72
    v_cmp_gt_u32 vcc, 16, v2
    s_cmp_ge_u32 s3, 6
    s_cselect_b64 s[18:19], s[86:87], s[82:83]
    v_mov_b32 v196, 0
    v_mov_b32 v198, 0
    v_mov_b32 v200, 0
    v_mov_b32 v202, 0
    v_mov_b32 v204, 0
    v_mov_b32 v206, 0
    v_cndmask_b32 v197, v45, -1, s[18:19]
    v_mov_b32 v201, -1
    v_cndmask_b32 v205, v45, -1, vcc
    v_cndmask_b32 v199, v45, -1, s[18:19]
    v_mov_b32 v203, -1
    v_cndmask_b32 v207, v45, -1, vcc
    s_branch L_D_bar2
    s_cmp_eq_u32 s3, 7
    s_cselect_b32 s62, 1, s93
    s_cmp_eq_u32 s62, 0
    s_cbranch_scc1 L_D_bar2
    v_cmp_gt_u32 vcc, 16, v2
    s_movk_i32 s62, 9216
    v_mul_lo_u32 v15, v2, s62
    v_cndmask_b32 v204, 0, -1, vcc
    s_and_b32 s62, s100, 3
    s_mul_i32 s74, s62, 2304
    s_lshr_b32 s62, s100, 2
    s_lshl_b32 s62, s62, 6
    s_add_u32 s74, s74, s62
    s_add_u32 s74, s74, 1916928
    s_and_b64 s[16:17], s[86:87], 0xffff
    s_sleep 40
    s_mov_b32 s70, 0
    s_branch L_pollS
L_pollS_pre:
    s_sleep 2
L_pollS:
    s_mov_b64 exec, s[16:17]
    s_cmp_lg_u32 s93, 0
    s_cbranch_scc1 L_nov30
    buffer_load_dword v204, v15, s[20:23], s74 offen sc1
L_nov30:
    s_mov_b64 exec, s[86:87]
    s_add_u32 s70, s70, 1
    s_cmp_lt_u32 s70, 2
    s_cbranch_scc1 L_pollS_pre
    s_waitcnt vmcnt(1)
    v_cmp_eq_u32 s[16:17], -1, v204
    s_bcnt1_i32_b64 s68, s[16:17]
    s_cmp_gt_u32 s68, 4
    s_cbranch_scc0 L_pollS_done
    s_cmp_lt_u32 s70, 20000
    s_cbranch_scc1 L_pollS
L_pollS_done:
L_D_bar2:
    s_mov_b64 s[12:13], s[18:19]
    s_mov_b64 s[14:15], s[86:87]
    s_and_b64 s[16:17], s[86:87], 0xffff
    s_cbranch_execz L_nobar31
    s_barrier
L_nobar31:
    ds_read_b32 v50, v16 offset:18240
    ds_read_b32 v51, v16 offset:18496
    ds_read_b32 v52, v16 offset:18752
    ds_read_b32 v53, v16 offset:19008
    ds_read_b32 v54, v16 offset:19264
    ds_read_b32 v55, v16 offset:19520
    s_waitcnt lgkmcnt(0)
    v_pk_add_f32 v[50:51], v[50:51], v[52:53]
    v_pk_add_f32 v[50:51], v[50:51], v[54:55]
    v_add_f32 v50, v50, v51
    s_cmp_ge_u32 s3, 6
    s_cbranch_scc1 L_D_stats
    s_mov_b32 s70, 0
    s_branch L_pollD
L_pollD_pre:
    s_sleep 2
L_pollD:
    s_mov_b64 exec, s[12:13]
    s_cmp_lg_u32 s93, 0
    s_cbranch_scc1 L_nov32
    buffer_load_dwordx4 v[196:199], v14, s[20:23], s73 offen sc1
L_nov32:
    s_mov_b64 exec, s[86:87]
    s_add_u32 s70, s70, 1
    s_cmp_lt_u32 s70, 2
    s_cbranch_scc1 L_pollD_pre
    s_waitcnt vmcnt(1)
    v_cmp_ne_u32 s[80:81], s60, v197
    v_cmp_ne_u32 s[12:13], s60, v199
    s_or_b64 s[12:13], s[12:13], s[80:81]
    s_cbranch_scc0 L_pollD_done
    s_cmp_lt_u32 s70, 20000
    s_cbranch_scc1 L_pollD
L_pollD_done:
    v_mov_b32_dpp v26, v196 row_shl:4 row_mask:0xf bank_mask:0xf
    v_mov_b32_dpp v27, v198 row_shl:4 row_mask:0xf bank_mask:0xf
    v_mov_b32 v24, v196
    v_mov_b32 v25, v198
    s_nop 1
    v_mfma_f32_16x16x32_bf16 v[160:163], v[24:27], v[80:83], 0
    v_mfma_f32_16x16x32_bf16 v[164:167], v[24:27], v[84:87], 0
    v_mfma_f32_16x16x32_bf16 v[168:171], v[24:27], v[88:91], 0
    v_mfma_f32_16x16x32_bf16 v[172:175], v[24:27], v[92:95], 0
    v_mfma_f32_16x16x32_bf16 v[176:179], v[24:27], v[96:99], 0
    v_mfma_f32_16x16x32_bf16 v[180:183], v[24:27], v[100:103], 0
    s_nop 4
    v_add_f32 v20, v160, v169
    v_add_f32 v21, v164, v173
    v_add_f32 v20, v20, v178
    v_add_f32 v21, v21, v182
    ds_write_b64 v17, v[20:21] offset:14144
    s_cbranch_execnz L_D_bar3
L_D_stats:
    s_cmp_eq_u32 s3, 7
    s_cselect_b32 s62, 1, s93
    s_cmp_eq_u32 s62, 0
    s_cbranch_scc1 L_D_bar3
    v_mov_b32 v60, 0x3f803f80
    v_mov_b32 v31, 0x3ae38e39
    v_lshlrev_b32 v15, 3, v2
    v_and_b32 v21, 3, v2
    v_lshrrev_b32 v14, 2, v2
    v_lshlrev_b32 v14, 7, v14
    v_lshl_add_u32 v14, v21, 4, v14
    s_add_u32 s73, s72, 2048
    s_mov_b32 s70, 0
    s_branch L_pollT
L_pollT_pre:
    s_sleep 2
L_pollT:
    s_mov_b64 exec, s[12:13]
    s_cmp_lg_u32 s93, 0
    s_cbranch_scc1 L_nov33
    buffer_load_dwordx4 v[196:199], v6, s[20:23], s72 offen offset:0 sc1
L_nov33:
    s_mov_b64 exec, s[14:15]
    s_cmp_lg_u32 s93, 0
    s_cbranch_scc1 L_nov34
    buffer_load_dwordx4 v[200:203], v6, s[20:23], s72 offen offset:1024 sc1
L_nov34:
    s_mov_b64 exec, s[16:17]
    s_cmp_lg_u32 s93, 0
    s_cbranch_scc1 L_nov35
    buffer_load_dwordx4 v[204:207], v6, s[20:23], s72 offen offset:2048 sc1
L_nov35:
    s_mov_b64 exec, s[86:87]
    s_add_u32 s70, s70, 1
    s_cmp_lt_u32 s70, 2
    s_cbranch_scc1 L_pollT_pre
    s_waitcnt vmcnt(3)
    v_cmp_ne_u32 s[12:13], s60, v197
    v_cmp_ne_u32 s[24:25], s60, v199
    v_cmp_ne_u32 s[14:15], s60, v201
    v_cmp_ne_u32 s[26:27], s60, v203
    v_cmp_ne_u32 s[16:17], s60, v205
    v_cmp_ne_u32 s[28:29], s60, v207
    s_or_b64 s[12:13], s[12:13], s[24:25]
    s_or_b64 s[14:15], s[14:15], s[26:27]
    s_or_b64 s[16:17], s[16:17], s[28:29]
    s_or_b64 s[80:81], s[12:13], s[14:15]
    s_or_b64 s[80:81], s[80:81], s[16:17]
    s_cbranch_scc0 L_pollT_done
    s_cmp_lt_u32 s70, 20000
    s_cbranch_scc1 L_pollT
L_pollT_done:
    v_dot2_f32_bf16 v20, v196, v60, 0
    v_dot2_f32_bf16 v21, v196, v196, 0
    v_dot2_f32_bf16 v20, v198, v60, v20
    v_dot2_f32_bf16 v21, v198, v198, v21
    v_dot2_f32_bf16 v20, v200, v60, v20
    v_dot2_f32_bf16 v21, v200, v200, v21
    v_dot2_f32_bf16 v20, v202, v60, v20
    v_dot2_f32_bf16 v21, v202, v202, v21
    v_dot2_f32_bf16 v20, v204, v60, v20
    v_dot2_f32_bf16 v21, v204, v204, v21
    v_dot2_f32_bf16 v20, v206, v60, v20
    v_dot2_f32_bf16 v21, v206, v206, v21
    s_nop 2
    v_permlane32_swap_b32 v20, v21
    s_nop 0
    v_add_f32 v20, v20, v21
    v_mov_b32 v21, v20
    s_nop 1
    v_permlane16_swap_b32 v20, v21
    s_nop 0
    v_add_f32 v20, v20, v21
    s_nop 1
    v_add_f32_dpp v20, v20, v20 quad_perm:[1,0,3,2] row_mask:0xf bank_mask:0xf
    s_nop 1
    v_add_f32_dpp v20, v20, v20 quad_perm:[2,3,0,1] row_mask:0xf bank_mask:0xf
    s_nop 1
    v_add_f32_dpp v20, v20, v20 row_half_mirror row_mask:0xf bank_mask:0xf
    s_nop 1
    v_add_f32_dpp v20, v20, v20 row_mirror row_mask:0xf bank_mask:0xf
    v_mul_f32 v26, v20, v31
    v_mul_f32 v27, v20, v31
    s_nop 1
    v_permlane32_swap_b32 v26, v27
    s_nop 0
    v_fma_f32 v27, -v26, v26, v27
    v_cvt_pk_bf16_f32 v28, v26, v27
    v_and_b32 v27, 0xffff0000, v28
    v_lshlrev_b32 v26, 16, v28
    v_add_f32 v27, 0x3727c5ac, v27
    v_cvt_pk_bf16_f32 v27, v27, v27
    v_lshlrev_b32 v27, 16, v27
    v_sqrt_f32 v27, v27
    s_nop 0
    v_cvt_pk_bf16_f32 v27, v27, v27
    v_lshlrev_b32 v27, 16, v27
    v_rcp_f32 v27, v27
    s_nop 0
    ds_write_b64 v15, v[26:27] offset:21312
L_D_bar3:
    s_waitcnt lgkmcnt(0)
    s_cbranch_execz L_nobar36
    s_barrier
L_nobar36:
    s_cmp_ge_u32 s3, 6
    s_cbranch_scc1 L_end
    ds_read_b64 v[26:27], v36 offset:21312
    ds_read_b32 v20, v18 offset:14144
    ds_read_b32 v21, v18 offset:14656
    ds_read_b32 v22, v18 offset:15168
    ds_read_b32 v23, v18 offset:15680
    ds_read_b32 v24, v18 offset:16192
    ds_read_b32 v25, v18 offset:16704
    s_waitcnt lgkmcnt(5)
    v_fma_f32 v20, -v26, v50, v20
    s_waitcnt lgkmcnt(0)
    v_pk_add_f32 v[22:23], v[22:23], v[24:25]
    v_pk_add_f32 v[20:21], v[20:21], v[22:23]
    v_add_f32 v20, v20, v21
    v_mul_f32 v20, v20, v27
    v_cvt_pk_bf16_f32 v20, v20, v20
    v_lshlrev_b32 v20, 16, v20
    v_add_f32 v20, v20, v61
    v_cvt_pk_bf16_f32 v20, v20, v20
    v_lshlrev_b32 v20, 16, v20
    v_max_f32 v20, 0, v20
    v_mul_f32 v20, v20, v20
    s_nop 1
    v_mov_b32_dpp v21, v20 quad_perm:[1,0,3,2] row_mask:0xf bank_mask:0xf
    v_cvt_pk_bf16_f32 v22, v20, v21
    s_nop 1
    v_mov_b32_dpp v24, v22 row_newbcast:0 row_mask:0xf bank_mask:0xf
    v_mov_b32_dpp v25, v22 row_newbcast:2 row_mask:0xf bank_mask:0xf
    v_mov_b32_dpp v26, v22 row_newbcast:4 row_mask:0xf bank_mask:0xf
    v_mov_b32_dpp v27, v22 row_newbcast:6 row_mask:0xf bank_mask:0xf
    s_nop 1
    v_mfma_f32_16x16x32_bf16 v[160:163], v[24:27], v[104:107], 0
    v_mfma_f32_16x16x32_bf16 v[164:167], v[24:27], v[108:111], 0
    v_mfma_f32_16x16x32_bf16 v[168:171], v[24:27], v[112:115], 0
    v_mfma_f32_16x16x32_bf16 v[172:175], v[24:27], v[116:119], 0
    v_mfma_f32_16x16x32_bf16 v[176:179], v[24:27], v[120:123], 0
    v_mfma_f32_16x16x32_bf16 v[180:183], v[24:27], v[124:127], 0
    s_nop 2
    v_mov_b32_dpp v160, v164 quad_perm:[0,1,2,3] row_mask:0x2 bank_mask:0xf
    s_nop 0
    v_mov_b32_dpp v160, v168 quad_perm:[0,1,2,3] row_mask:0x4 bank_mask:0xf
    s_nop 0
    v_mov_b32_dpp v160, v172 quad_perm:[0,1,2,3] row_mask:0x8 bank_mask:0xf
    v_and_or_b32 v160, v160, s46, v46
    s_cbranch_execz L_nov37
    buffer_store_dword v160, v19, s[20:23], s71 offen sc1
L_nov37:
    s_nop 3
    v_mov_b32_dpp v176, v180 quad_perm:[0,1,2,3] row_mask:0x2 bank_mask:0xf
    v_and_or_b32 v176, v176, s46, v46
    s_mov_b32 exec_hi, 0
    s_cbranch_execz L_nov38
    buffer_store_dword v176, v19, s[20:23], s33 offen offset:256 sc1
L_nov38:
    s_mov_b64 exec, s[86:87]
L_end:
    s_cmp_lg_u32 s93, 0
    s_cbranch_scc1 L_dry_ret
    s_endpgm
L_dry_ret:
    s_mov_b32 s93, 0
    s_mov_b32 s3, 5
    s_mov_b64 exec, -1
    s_mov_b64 s[86:87], -1
    s_setprio 2
    s_branch L_early
.section .rodata,"a"
.p2align 6
.amdhsa_kernel sequential_preLN__gqa_block_cached__dense_activation_squared_relu__decode_kernel
  .amdhsa_next_free_vgpr 256
  .amdhsa_next_free_sgpr 102
  .amdhsa_accum_offset 256
  .amdhsa_group_segment_fixed_size 0
  .amdhsa_kernarg_size 104
  .amdhsa_user_sgpr_count 2
  .amdhsa_user_sgpr_kernarg_segment_ptr 1
  .amdhsa_system_sgpr_workgroup_id_x 1
.end_amdhsa_kernel
```
